```python
import torch

def _softmax(x, axis=-1):
    return torch.softmax(x, dim=axis)
def _gelu(x):
    return torch.nn.functional.gelu(x, approximate="tanh")
def _silu(x):
    return torch.nn.functional.silu(x)
def _sigmoid(x):
    return torch.sigmoid(x)
def _layernorm(x, axis=-1, eps=1e-5):
    m = x.mean(dim=axis, keepdim=True)
    v = x.var(dim=axis, keepdim=True, unbiased=False)
    return (x - m) / torch.sqrt(v + eps)
def _scatter_add(tgt, idx, src, axis=0):
    return tgt.clone().index_add_(axis, idx, src)
def _segment_sum(src, seg, n):
    out = torch.zeros((n,) + src.shape[1:], dtype=src.dtype)
    return out.index_add_(0, seg, src)
def _pad(x, pw):
    flat = tuple(v for pair in reversed(pw) for v in pair)
    return torch.nn.functional.pad(x, flat)

kernel_name = 'standalone__edge_featured_mpnn_gatedgcn__graph'

def setup_inputs():

    _w = (lambda a: (lambda t: t.to(torch.bfloat16) if t.is_floating_point() else t)(torch.as_tensor(a)))
    N, deg, D, De = 10000, 32, 128, max(4, 1)
    E = N * deg
    return {
        "x": _w((lambda *s: torch.randn(*s, dtype=torch.bfloat16) * 0.4)(N, D)),
        "e_attr": _w((lambda *s: torch.randn(*s, dtype=torch.bfloat16) * 0.8)(E, De)),
        "src": _w((lambda lo, hi, *s: torch.randint(lo, hi, s))(0, N, E).to(torch.int64)),
        "dst": _w((lambda lo, hi, *s: torch.randint(lo, hi, s))(0, N, E).to(torch.int64)),
        "w_a": _w((lambda *s: torch.randn(*s, dtype=torch.bfloat16) * 0.4)(D, D)),
        "w_b": _w((lambda *s: torch.randn(*s, dtype=torch.bfloat16) * 0.4)(D, D)),
        "w_c": _w((lambda *s: torch.randn(*s, dtype=torch.bfloat16) * 0.8)(De, D)),
        "w_u": _w((lambda *s: torch.randn(*s, dtype=torch.bfloat16) * 0.05)(D, D)),
        "w_v": _w((lambda *s: torch.randn(*s, dtype=torch.bfloat16) * 0.05)(D, D)),
    }

def reference(x, e_attr, src, dst, w_a, w_b, w_c, w_u, w_v):
    N, D = x.shape
    hv = x @ w_v
    g = x[dst] @ w_a + x[src] @ w_b + e_attr @ w_c
    eta = _sigmoid(g)
    denom = _segment_sum(eta, dst, N) + 1e-6
    eta_n = eta / denom[dst]
    agg = _segment_sum(eta_n * hv[src], dst, N)
    z = x @ w_u + agg
    relu_z = torch.where(z > 0, z, 0 * z)
    return x + relu_z
```

```asm
; @launch grid=(256,1,1) block=(1024,1,1) lds=160512
.amdgcn_target "amdgcn-amd-amdhsa--gfx950"
.text
.globl standalone__edge_featured_mpnn_gatedgcn__graph_kernel
.p2align 8
.type standalone__edge_featured_mpnn_gatedgcn__graph_kernel,@function
standalone__edge_featured_mpnn_gatedgcn__graph_kernel:
    s_memrealtime s[42:43]
    s_load_dwordx16 s[4:19], s[0:1], 0
    s_load_dwordx8 s[20:27], s[0:1], 64
    s_getpc_b64 s[80:81]
L_pc:
    v_lshlrev_b32 v63, 4, v0
    v_min_u32 v8, L_end-L_pc, v63
    global_load_dword v118, v8, s[80:81]
    s_cmpk_ge_u32 s2, 256
    s_cbranch_scc1 L_end
    v_mov_b64 v[4:5], 0
    v_mov_b64 v[6:7], 0
    ds_write_b128 v63, v[4:7]
    s_mul_i32 s3, s2, 5000
    v_cmp_gt_u32 vcc, 320, v0
    s_cbranch_vccz L_roleG
    v_min_u32 v63, 4984, v63
    v_add_u32 v63, s3, v63
    v_lshlrev_b32 v62, 1, v63
    s_setprio 3
    s_waitcnt lgkmcnt(0)
    global_load_dwordx4 v[12:15], v63, s[10:11]
    global_load_dwordx4 v[16:19], v63, s[8:9]
    global_load_dwordx4 v[20:23], v62, s[6:7]
    global_load_dwordx4 v[24:27], v62, s[6:7] offset:16
    s_barrier
    v_lshrrev_b32 v10, 6, v0
    v_and_b32 v1, 63, v0
    v_readfirstlane_b32 s28, v10
    v_mov_b32 v2, 1
    s_and_b32 s30, s2, 1
    s_bfe_u32 s31, s2, 0x20001
    s_lshl_b32 s31, s31, 5
    s_lshr_b32 s29, s2, 3
    s_add_u32 s29, s29, s31
    s_mul_i32 s31, s29, 625
    s_add_u32 s0, s31, 7
    s_add_u32 s1, s31, 632
    s_lshr_b32 s0, s0, 3
    s_lshr_b32 s1, s1, 3
    s_sub_u32 s1, s1, s0
    s_lshl_b32 s0, s0, 8
    v_and_b32 v110, 15, v0
    v_bfe_u32 v111, v0, 4, 2
    v_lshlrev_b32 v93, 3, v1
    s_mul_i32 s31, s2, 1152
    s_lshl_b32 s72, s28, 8
    s_add_u32 s31, s31, s72
    s_add_u32 s31, s31, 226492416
    s_mul_i32 s72, s30, 128
    s_add_u32 s72, s72, s29
    s_lshl_b32 s72, s72, 7
    s_add_u32 s72, s72, 226787328
    s_cmp_eq_u32 s28, 4
    s_cselect_b32 s31, s72, s31
    s_bfe_u32 s72, s42, 0x5000b
    s_mul_i32 s72, s72, 393216
    s_add_u32 s31, s31, s72
    s_cmp_eq_u32 s28, 4
    v_lshl_add_u32 v61, v1, 4, s31
    s_cselect_b32 exec_lo, 0xff, -1
    s_and_b64 exec, exec, 0xffff
    global_store_dwordx4 v61, v[4:7], s[26:27] sc1
    s_mov_b64 exec, -1
    s_movk_i32 s3, 312
    v_cmp_gt_u32 s[76:77], s3, v0
    v_cmp_ge_u32 s[80:81], s3, v0
    s_movk_i32 s31, 625
    s_mov_b32 s72, 3072
    s_mul_i32 s3, s28, 3072
    v_lshl_add_u32 v56, v1, 4, s3
    v_add_u32 v57, 3072, v56
    s_bfe_u32 s3, s42, 0x5000b
    v_mov_b32 v32, s3
    s_cmp_eq_u32 s28, 0
    s_cselect_b64 exec, 1, 0
    ds_write_b32 v4, v32 offset:2224
    s_mov_b64 exec, -1
    s_waitcnt vmcnt(4)
    v_mul_u32_u24 v40, 107375, v12
    v_mul_u32_u24 v41, 107375, v13
    v_mul_u32_u24 v42, 107375, v14
    v_mul_u32_u24 v43, 107375, v15
    v_lshrrev_b32 v40, 23, v40
    v_lshrrev_b32 v41, 23, v41
    v_lshrrev_b32 v42, 23, v42
    v_lshrrev_b32 v43, 23, v43
    v_lshlrev_b32 v28, 2, v40
    v_lshlrev_b32 v29, 2, v41
    v_lshlrev_b32 v30, 2, v42
    v_lshlrev_b32 v31, 2, v43
    s_mov_b64 exec, s[76:77]
    ds_add_rtn_u32 v8, v28, v2 offset:0
    ds_add_rtn_u32 v9, v29, v2 offset:0
    s_mov_b64 exec, s[80:81]
    ds_add_rtn_u32 v10, v30, v2 offset:0
    ds_add_rtn_u32 v11, v31, v2 offset:0
    s_mov_b64 exec, -1
    s_waitcnt lgkmcnt(0)
    s_mov_b64 exec, 1
    ds_add_rtn_u32 v32, v4, v2 offset:2188
    s_mov_b64 exec, -1
    ds_read_b64 v[34:35], v93 offset:0
    ds_read_b32 v33, v4 offset:2224
    v_mad_u32_u24 v40, v40, s31, 7
    v_mad_u32_u24 v41, v41, s31, 7
    v_mad_u32_u24 v42, v42, s31, 7
    v_mad_u32_u24 v43, v43, s31, 7
    v_lshrrev_b32 v40, 3, v40
    v_lshrrev_b32 v41, 3, v41
    v_lshrrev_b32 v42, 3, v42
    v_lshrrev_b32 v43, 3, v43
    v_sub_u32 v12, v12, v40
    v_sub_u32 v13, v13, v41
    v_sub_u32 v14, v14, v42
    v_sub_u32 v15, v15, v43
    s_waitcnt lgkmcnt(0)
    v_readfirstlane_b32 s3, v32
    s_cmp_eq_u32 s3, 4
    s_cbranch_scc1 L_ls_p1
L_lw_p1:
    ds_read_b32 v32, v4 offset:2188
    ds_read_b64 v[34:35], v93 offset:0
    ds_read_b32 v33, v4 offset:2224
    s_waitcnt lgkmcnt(0)
    v_readfirstlane_b32 s3, v32
    s_cmp_ge_u32 s3, 5
    s_cbranch_scc0 L_lw_p1
L_ls_p1:
    v_add_u32 v36, v34, v35
    v_add_u32 v37, v34, v35
    s_nop 1
    v_add_u32_dpp v37, v37, v37 row_shr:1 row_mask:0xf bank_mask:0xf
    s_nop 1
    v_add_u32_dpp v37, v37, v37 row_shr:2 row_mask:0xf bank_mask:0xf
    s_nop 1
    v_add_u32_dpp v37, v37, v37 row_shr:4 row_mask:0xf bank_mask:0xf
    s_nop 1
    v_add_u32_dpp v37, v37, v37 row_shr:8 row_mask:0xf bank_mask:0xf
    s_nop 1
    v_add_u32_dpp v37, v37, v37 row_bcast:15 row_mask:0xa bank_mask:0xf
    s_nop 1
    v_add_u32_dpp v37, v37, v37 row_bcast:31 row_mask:0xc bank_mask:0xf
    v_sub_u32 v38, v37, v36
    v_add_u32 v39, v38, v34
    ds_write_b64 v93, v[38:39] offset:512
    ds_read_b32 v40, v28 offset:512
    ds_read_b32 v41, v29 offset:512
    ds_read_b32 v42, v30 offset:512
    ds_read_b32 v43, v31 offset:512
    v_readfirstlane_b32 s73, v33
    s_mul_i32 s3, s2, 15360
    s_add_u32 s3, s3, 92274688
    s_lshl_b32 s73, s73, 22
    s_add_u32 s3, s3, s73
    s_add_u32 s78, s26, s3
    s_addc_u32 s79, s27, 0
    s_waitcnt vmcnt(1)
    v_lshl_or_b32 v16, v12, 16, v16
    v_lshl_or_b32 v17, v13, 16, v17
    v_lshl_or_b32 v18, v14, 16, v18
    v_lshl_or_b32 v19, v15, 16, v19
    s_mov_b64 exec, s[76:77]
    s_waitcnt lgkmcnt(3)
    v_add_u32 v40, v40, v8
    v_mad_u32_u24 v40, v40, 12, s72
    ds_write2_b32 v40, v20, v21 offset0:0 offset1:1
    ds_write_b32 v40, v16 offset:8
    s_waitcnt lgkmcnt(4)
    v_add_u32 v41, v41, v9
    v_mad_u32_u24 v41, v41, 12, s72
    ds_write2_b32 v41, v22, v23 offset0:0 offset1:1
    ds_write_b32 v41, v17 offset:8
    s_mov_b64 exec, s[80:81]
    s_waitcnt lgkmcnt(5)
    v_add_u32 v42, v42, v10
    v_mad_u32_u24 v42, v42, 12, s72
    ds_write2_b32 v42, v24, v25 offset0:0 offset1:1
    ds_write_b32 v42, v18 offset:8
    s_waitcnt lgkmcnt(6)
    v_add_u32 v43, v43, v11
    v_mad_u32_u24 v43, v43, 12, s72
    ds_write2_b32 v43, v26, v27 offset0:0 offset1:1
    ds_write_b32 v43, v19 offset:8
    s_mov_b64 exec, -1
    s_waitcnt lgkmcnt(0)
    s_mov_b64 exec, 1
    ds_add_rtn_u32 v32, v4, v2 offset:2192
    s_mov_b64 exec, -1
    ds_read_b128 v[44:47], v57 offset:0
    ds_read_b128 v[48:51], v57 offset:1024
    ds_read_b128 v[52:55], v57 offset:2048
    s_waitcnt lgkmcnt(0)
    v_readfirstlane_b32 s3, v32
    s_cmp_eq_u32 s3, 4
    s_cbranch_scc1 L_ls_p2
L_lw_p2:
    ds_read_b32 v32, v4 offset:2192
    ds_read_b128 v[44:47], v57 offset:0
    ds_read_b128 v[48:51], v57 offset:1024
    ds_read_b128 v[52:55], v57 offset:2048
    s_waitcnt lgkmcnt(0)
    v_readfirstlane_b32 s3, v32
    s_cmp_ge_u32 s3, 5
    s_cbranch_scc0 L_lw_p2
L_ls_p2:
    global_store_dwordx4 v56, v[44:47], s[78:79] offset:0 sc1
    global_store_dwordx4 v56, v[48:51], s[78:79] offset:1024 sc1
    global_store_dwordx4 v56, v[52:55], s[78:79] offset:2048 sc1
    s_mov_b64 exec, 1
    ds_add_u32 v4, v2 offset:2200
    s_mov_b64 exec, -1
    s_call_b64 s[74:75], L_consts
L_nl_p:
    ds_read_b64 v[40:41], v4 offset:2216
    s_waitcnt lgkmcnt(0)
    v_readfirstlane_b32 s40, v40
    v_readfirstlane_b32 s41, v41
    s_cmp_lg_u32 s40, 0
    s_cbranch_scc0 L_nl_p
    s_bfe_u32 s82, s40, 0x40001
    s_mul_i32 s82, s82, 5767168
    s_bfe_u32 s83, s40, 0x5000b
    s_mul_i32 s83, s83, 393216
    s_add_u32 s36, s36, s82
    s_addc_u32 s37, s37, 0
    v_add_u32 v119, s82, v119
    v_add_u32 v114, s83, v114
    v_add_u32 v109, s83, v109
    s_mul_i32 s3, s2, 1152
    s_add_u32 s3, s3, 226492416
    s_add_u32 s3, s3, s83
    s_add_u32 s78, s26, s3
    s_addc_u32 s79, s27, 0
    v_lshl_or_b32 v58, v34, 11, v38
    v_lshl_or_b32 v60, v35, 11, v39
    v_lshlrev_b32 v56, 4, v1
    v_lshl_or_b32 v58, v33, 22, v58
    v_lshl_or_b32 v60, v33, 22, v60
    v_or_b32 v58, s41, v58
    v_or_b32 v60, s41, v60
    v_mov_b32 v59, s40
    v_mov_b32 v61, s40
    s_mov_b64 exec, 1
    s_waitcnt vmcnt(0)
    ds_add_rtn_u32 v42, v4, v2 offset:2176
    s_mov_b64 exec, -1
    s_waitcnt lgkmcnt(0)
    v_readfirstlane_b32 s3, v42
    s_cmp_eq_u32 s3, 4
    s_cbranch_scc0 L_p_done
    global_store_dwordx4 v56, v[58:61], s[78:79] sc1
L_p_done:
    s_setprio 0
    s_branch L_poll1
L_consts:
    s_sub_u32 s3, s28, 5
    s_cmp_lt_u32 s28, 5
    s_cselect_b32 s73, s28, s3
    s_cmp_lt_u32 s3, 5
    s_cselect_b32 s73, 11, s73
    s_mul_i32 s3, s73, 24
    v_add_u32 v64, s3, v111
    v_lshl_add_u32 v65, v110, 2, v64
    v_cmp_gt_u32 vcc, 256, v65
    s_mov_b32 s76, 0x3f003f
    s_mov_b32 s77, s76
    s_and_b64 s[76:77], s[76:77], vcc
    v_mul_u32_u24 v114, 1152, v65
    s_lshl_b32 s31, s29, 3
    s_add_u32 s31, s31, 226492416
    v_add_u32 v114, s31, v114
    v_mov_b32 v112, 0
    v_mul_u32_u24 v115, 15360, v64
    v_mad_u32_u24 v115, v110, 12, v115
    s_add_u32 s68, s26, 92274688
    s_addc_u32 s69, s27, 0
    s_mov_b32 s70, 134217728
    s_mov_b32 s71, 0x20000
    s_mul_i32 s72, s30, 2592768
    s_add_u32 s36, s26, s72
    s_addc_u32 s37, s27, 0
    s_or_b32 s37, s37, 16777216
    s_mov_b32 s38, 10128
    s_mov_b32 s39, 0x20000
    s_mov_b32 s10, 61440
    s_mov_b32 s11, 122880
    s_mov_b32 s12, 184320
    s_mov_b32 s13, 245760
    s_mov_b32 s14, 307200
    s_mov_b32 s16, 0
    s_mov_b32 s17, 0
    s_mov_b64 s[84:85], -1
    s_mul_i32 s3, s73, 12
    v_add_u32 v64, s3, v1
    v_cmp_gt_u32 vcc, 128, v64
    s_and_b64 s[6:7], vcc, 0xfff
    s_mul_i32 s31, s30, 16384
    s_add_u32 s31, s31, 226787328
    v_lshl_add_u32 v109, v64, 7, s31
    v_mul_u32_u24 v65, 43, v1
    v_lshrrev_b32 v65, 9, v65
    v_mul_u32_u24 v66, 12, v65
    v_sub_u32 v64, v64, v66
    v_cmp_gt_u32 vcc, 128, v64
    s_bfm_b64 s[8:9], 24, 0
    s_and_b64 s[8:9], s[8:9], vcc
    v_mul_u32_u24 v64, 625, v64
    v_add_u32 v64, 7, v64
    v_lshrrev_b32 v64, 3, v64
    v_lshlrev_b32 v64, 8, v64
    v_add_u32 v64, s72, v64
    s_lshr_b32 s3, s2, 3
    s_mul_i32 s3, s3, 5
    s_and_b32 s3, s3, -2
    v_add_u32 v65, s3, v65
    v_lshl_add_u32 v119, v65, 7, v64
    v_lshlrev_b32 v93, 3, v1
    v_and_b32 v64, 1, v1
    v_lshlrev_b32 v64, 4, v64
    v_mov_b32 v65, 0x3f80
    v_lshlrev_b32 v64, v64, v65
    v_and_b32 v65, 2, v1
    v_cmp_eq_u32 vcc, 0, v65
    v_bfe_u32 v66, v1, 2, 2
    v_cmp_eq_u32 s[80:81], v66, v111
    v_cndmask_b32 v100, 0, v64, vcc
    v_cndmask_b32 v101, v64, 0, vcc
    v_and_b32 v65, 3, v1
    v_cndmask_b32 v90, 0, v100, s[80:81]
    v_cndmask_b32 v91, 0, v101, s[80:81]
    v_cndmask_b32 v94, 0, v100, s[80:81]
    v_cndmask_b32 v95, 0, v101, s[80:81]
    v_cmp_eq_u32 vcc, v65, v111
    v_mov_b32 v102, 0x21802180
    v_mov_b32 v103, 0x21802180
    v_cndmask_b32 v106, 0, 32, vcc
    v_lshlrev_b32 v97, 4, v110
    v_lshlrev_b32 v99, 4, v110
    v_mov_b32 v108, 2048
    v_mov_b32 v3, 8
    s_lshl_b32 s31, s28, 2
    v_add_u32 v126, s31, v111
    v_mul_u32_u24 v125, 528, v126
    v_lshl_add_u32 v125, v110, 2, v125
    v_add_u32 v125, 126720, v125
    v_lshlrev_b32 v127, 2, v110
    v_add_u32 v127, 2288, v127
    v_and_b32 v64, 28, v1
    v_mov_b32 v65, 0x31130220
    v_bfe_u32 v66, v65, v64, 2
    v_lshrrev_b32 v64, 5, v1
    v_lshl_add_u32 v66, v64, 2, v66
    s_lshl_b32 s31, s28, 3
    v_add_u32 v66, s31, v66
    v_bfe_u32 v64, v1, 3, 1
    v_and_b32 v67, 3, v1
    v_lshl_add_u32 v67, v64, 2, v67
    v_cmp_gt_u32 vcc, s1, v66
    s_cmp_lt_u32 s28, 10
    s_cbranch_scc0 L_c_noom
    s_mov_b64 s[34:35], vcc
L_c_noom:
    v_lshlrev_b32 v68, 4, v67
    v_lshl_add_u32 v68, v66, 8, v68
    s_lshl_b32 s72, s30, 7
    s_add_u32 s31, s0, s72
    v_add_u32 v120, s31, v68
    v_mul_u32_u24 v124, 784, v66
    v_add_u32 v124, 3072, v124
    v_lshl_add_u32 v121, v67, 5, v124
    v_lshlrev_b32 v68, 5, v67
    v_add_u32 v123, 126720, v68
    v_and_b32 v68, 1, v66
    v_lshl_or_b32 v68, v67, 1, v68
    v_lshlrev_b32 v68, 4, v68
    v_lshl_add_u32 v68, v66, 8, v68
    v_add_u32 v122, 65792, v68
    s_mov_b64 s[42:43], 0
    s_mov_b64 s[44:45], 0
    s_mov_b64 s[46:47], 0
    s_mov_b64 s[48:49], 0
    s_mov_b64 s[50:51], 0
    s_mov_b64 s[52:53], 0
    s_mov_b64 s[54:55], 0
    s_mov_b64 s[56:57], 0
    s_mov_b64 s[58:59], 0
    s_mov_b64 s[60:61], 0
    s_mov_b64 s[62:63], 0
    s_mov_b64 s[64:65], 0
    s_mov_b64 s[66:67], 0
    s_setpc_b64 s[74:75]
L_roleG:
    v_lshrrev_b32 v10, 6, v0
    v_and_b32 v1, 63, v0
    v_readfirstlane_b32 s28, v10
    v_mov_b32 v2, 1
    s_and_b32 s30, s2, 1
    s_bfe_u32 s31, s2, 0x20001
    s_lshl_b32 s31, s31, 5
    s_lshr_b32 s29, s2, 3
    s_add_u32 s29, s29, s31
    s_mul_i32 s31, s29, 625
    s_add_u32 s0, s31, 7
    s_add_u32 s1, s31, 632
    s_lshr_b32 s0, s0, 3
    s_lshr_b32 s1, s1, 3
    s_sub_u32 s1, s1, s0
    s_lshl_b32 s0, s0, 8
    v_and_b32 v110, 15, v0
    v_bfe_u32 v111, v0, 4, 2
    s_mov_b32 s35, 0x20000
    s_cmp_ge_u32 s28, 10
    s_cbranch_scc1 L_roleD
    v_xor_b32 v10, v110, v111
    v_lshlrev_b32 v10, 4, v10
    v_lshl_add_u32 v11, v111, 8, v10
    s_mov_b32 s34, 2560000
    s_sub_u32 s31, s28, 5
    s_lshl_b32 s31, s31, 12
    s_add_u32 s72, s0, s31
    s_add_u32 m0, s31, 65792
    v_xor_b32 v12, 64, v11
    v_xor_b32 v13, 128, v11
    v_xor_b32 v14, 192, v11
    s_waitcnt lgkmcnt(0)
    s_mov_b32 s32, s4
    s_mov_b32 s33, s5
    s_barrier
L_lw_gx:
    ds_read_b32 v15, v4 offset:2188
    s_waitcnt lgkmcnt(0)
    v_readfirstlane_b32 s3, v15
    s_cmp_ge_u32 s3, 1
    s_cbranch_scc0 L_lw_gx
    buffer_load_dwordx4 v11, s[32:35], s72 offen  lds
    s_add_u32 m0, m0, 1024
    s_add_u32 s72, s72, 1024
    buffer_load_dwordx4 v12, s[32:35], s72 offen  lds
    s_add_u32 m0, m0, 1024
    s_add_u32 s72, s72, 1024
    buffer_load_dwordx4 v13, s[32:35], s72 offen  lds
    s_add_u32 m0, m0, 1024
    s_add_u32 s72, s72, 1024
    buffer_load_dwordx4 v14, s[32:35], s72 offen  lds
    s_mov_b64 exec, 1
    ds_add_u32 v4, v2 offset:2204
    s_mov_b64 exec, -1
    s_call_b64 s[74:75], L_consts
    s_sub_u32 s73, s28, 5
    s_lshl_b32 s75, s73, 12
    s_add_u32 s75, s75, 65792
    v_lshl_add_u32 v10, v110, 8, v10
    v_xor_b32 v12, 0, v10
    v_add_u32 v12, s75, v12
    v_xor_b32 v13, 64, v10
    v_add_u32 v13, s75, v13
    v_xor_b32 v14, 128, v10
    v_add_u32 v14, s75, v14
    v_xor_b32 v15, 192, v10
    v_add_u32 v15, s75, v15
    v_bfe_u32 v8, v1, 2, 2
    v_lshl_add_u32 v9, v111, 3, v8
    v_lshlrev_b32 v9, 7, v9
    v_and_b32 v10, 3, v1
    v_lshl_add_u32 v9, v10, 3, v9
    v_add_u32 v9, 86272, v9
    v_lshrrev_b32 v8, 1, v8
    v_and_b32 v10, 1, v111
    v_lshl_or_b32 v8, v10, 1, v8
    v_xor_b32 v10, 0, v8
    v_lshl_add_u32 v96, v10, 5, v9
    v_xor_b32 v10, 1, v8
    v_lshl_add_u32 v98, v10, 5, v9
    v_xor_b32 v10, 2, v8
    v_lshl_add_u32 v104, v10, 5, v9
    v_xor_b32 v10, 3, v8
    v_lshl_add_u32 v105, v10, 5, v9
    s_mul_i32 s31, s30, 2592768
    s_add_u32 s31, s31, s0
    s_lshl_b32 s72, s73, 12
    s_add_u32 s31, s31, s72
    s_mov_b32 s78, s31
    v_lshlrev_b32 v8, 4, v110
    v_lshl_add_u32 v8, v111, 10, v8
    s_mov_b32 s80, 0xbfb8aa3b
    s_mov_b32 s74, 0
    s_setprio 2
    s_waitcnt vmcnt(0)
    ds_read_b128 v[16:19], v12
    ds_read_b128 v[20:23], v13
    ds_read_b128 v[24:27], v14
    ds_read_b128 v[28:31], v15
L_lw_g:
    ds_read_b32 v11, v4 offset:2196
    s_waitcnt lgkmcnt(0)
    v_readfirstlane_b32 s3, v11
    s_and_b32 s3, s3, 0xffff
    s_cmp_eq_u32 s3, 4
    s_cbranch_scc0 L_lw_g
L_gemm:
    ds_read_b64_tr_b16 v[64:65], v96 offset:0
    ds_read_b64_tr_b16 v[66:67], v96 offset:512
    ds_read_b64_tr_b16 v[68:69], v98 offset:0
    ds_read_b64_tr_b16 v[70:71], v98 offset:512
    ds_read_b64_tr_b16 v[72:73], v104 offset:0
    ds_read_b64_tr_b16 v[74:75], v104 offset:512
    ds_read_b64_tr_b16 v[76:77], v105 offset:0
    ds_read_b64_tr_b16 v[78:79], v105 offset:512
    ds_read_b64_tr_b16 v[80:81], v96 offset:16384
    ds_read_b64_tr_b16 v[82:83], v96 offset:16896
    ds_read_b64_tr_b16 v[84:85], v98 offset:16384
    ds_read_b64_tr_b16 v[86:87], v98 offset:16896
    ds_read_b64_tr_b16 v[12:13], v104 offset:16384
    ds_read_b64_tr_b16 v[14:15], v104 offset:16896
    s_waitcnt lgkmcnt(10)
    v_mfma_f32_16x16x32_bf16 v[32:35], v[16:19], v[64:67], 0
    ds_read_b64_tr_b16 v[64:65], v105 offset:16384
    ds_read_b64_tr_b16 v[66:67], v105 offset:16896
    v_mfma_f32_16x16x32_bf16 v[36:39], v[16:19], v[68:71], 0
    ds_read_b64_tr_b16 v[68:69], v96 offset:4096
    ds_read_b64_tr_b16 v[70:71], v96 offset:4608
    s_waitcnt lgkmcnt(10)
    v_mfma_f32_16x16x32_bf16 v[40:43], v[16:19], v[72:75], 0
    ds_read_b64_tr_b16 v[72:73], v98 offset:4096
    ds_read_b64_tr_b16 v[74:75], v98 offset:4608
    v_mfma_f32_16x16x32_bf16 v[44:47], v[16:19], v[76:79], 0
    ds_read_b64_tr_b16 v[76:77], v104 offset:4096
    ds_read_b64_tr_b16 v[78:79], v104 offset:4608
    s_waitcnt lgkmcnt(10)
    v_mfma_f32_16x16x32_bf16 v[48:51], v[16:19], v[80:83], 0
    ds_read_b64_tr_b16 v[80:81], v105 offset:4096
    ds_read_b64_tr_b16 v[82:83], v105 offset:4608
    v_mfma_f32_16x16x32_bf16 v[52:55], v[16:19], v[84:87], 0
    ds_read_b64_tr_b16 v[84:85], v96 offset:20480
    ds_read_b64_tr_b16 v[86:87], v96 offset:20992
    s_waitcnt lgkmcnt(10)
    v_mfma_f32_16x16x32_bf16 v[56:59], v[16:19], v[12:15], 0
    ds_read_b64_tr_b16 v[12:13], v98 offset:20480
    ds_read_b64_tr_b16 v[14:15], v98 offset:20992
    v_mfma_f32_16x16x32_bf16 v[60:63], v[16:19], v[64:67], 0
    ds_read_b64_tr_b16 v[64:65], v104 offset:20480
    ds_read_b64_tr_b16 v[66:67], v104 offset:20992
    s_waitcnt lgkmcnt(10)
    v_mfma_f32_16x16x32_bf16 v[32:35], v[20:23], v[68:71], v[32:35]
    ds_read_b64_tr_b16 v[68:69], v105 offset:20480
    ds_read_b64_tr_b16 v[70:71], v105 offset:20992
    v_mfma_f32_16x16x32_bf16 v[36:39], v[20:23], v[72:75], v[36:39]
    ds_read_b64_tr_b16 v[72:73], v96 offset:8192
    ds_read_b64_tr_b16 v[74:75], v96 offset:8704
    s_waitcnt lgkmcnt(10)
    v_mfma_f32_16x16x32_bf16 v[40:43], v[20:23], v[76:79], v[40:43]
    ds_read_b64_tr_b16 v[76:77], v98 offset:8192
    ds_read_b64_tr_b16 v[78:79], v98 offset:8704
    v_mfma_f32_16x16x32_bf16 v[44:47], v[20:23], v[80:83], v[44:47]
    ds_read_b64_tr_b16 v[80:81], v104 offset:8192
    ds_read_b64_tr_b16 v[82:83], v104 offset:8704
    s_waitcnt lgkmcnt(10)
    v_mfma_f32_16x16x32_bf16 v[48:51], v[20:23], v[84:87], v[48:51]
    ds_read_b64_tr_b16 v[84:85], v105 offset:8192
    ds_read_b64_tr_b16 v[86:87], v105 offset:8704
    v_mfma_f32_16x16x32_bf16 v[52:55], v[20:23], v[12:15], v[52:55]
    ds_read_b64_tr_b16 v[12:13], v96 offset:24576
    ds_read_b64_tr_b16 v[14:15], v96 offset:25088
    s_waitcnt lgkmcnt(10)
    v_mfma_f32_16x16x32_bf16 v[56:59], v[20:23], v[64:67], v[56:59]
    ds_read_b64_tr_b16 v[64:65], v98 offset:24576
    ds_read_b64_tr_b16 v[66:67], v98 offset:25088
    v_mfma_f32_16x16x32_bf16 v[60:63], v[20:23], v[68:71], v[60:63]
    ds_read_b64_tr_b16 v[68:69], v104 offset:24576
    ds_read_b64_tr_b16 v[70:71], v104 offset:25088
    s_waitcnt lgkmcnt(10)
    v_mfma_f32_16x16x32_bf16 v[32:35], v[24:27], v[72:75], v[32:35]
    ds_read_b64_tr_b16 v[72:73], v105 offset:24576
    ds_read_b64_tr_b16 v[74:75], v105 offset:25088
    v_mfma_f32_16x16x32_bf16 v[36:39], v[24:27], v[76:79], v[36:39]
    ds_read_b64_tr_b16 v[76:77], v96 offset:12288
    ds_read_b64_tr_b16 v[78:79], v96 offset:12800
    s_waitcnt lgkmcnt(10)
    v_mfma_f32_16x16x32_bf16 v[40:43], v[24:27], v[80:83], v[40:43]
    ds_read_b64_tr_b16 v[80:81], v98 offset:12288
    ds_read_b64_tr_b16 v[82:83], v98 offset:12800
    v_mfma_f32_16x16x32_bf16 v[44:47], v[24:27], v[84:87], v[44:47]
    ds_read_b64_tr_b16 v[84:85], v104 offset:12288
    ds_read_b64_tr_b16 v[86:87], v104 offset:12800
    s_waitcnt lgkmcnt(10)
    v_mfma_f32_16x16x32_bf16 v[48:51], v[24:27], v[12:15], v[48:51]
    ds_read_b64_tr_b16 v[12:13], v105 offset:12288
    ds_read_b64_tr_b16 v[14:15], v105 offset:12800
    v_mfma_f32_16x16x32_bf16 v[52:55], v[24:27], v[64:67], v[52:55]
    ds_read_b64_tr_b16 v[64:65], v96 offset:28672
    ds_read_b64_tr_b16 v[66:67], v96 offset:29184
    s_waitcnt lgkmcnt(10)
    v_mfma_f32_16x16x32_bf16 v[56:59], v[24:27], v[68:71], v[56:59]
    ds_read_b64_tr_b16 v[68:69], v98 offset:28672
    ds_read_b64_tr_b16 v[70:71], v98 offset:29184
    v_mfma_f32_16x16x32_bf16 v[60:63], v[24:27], v[72:75], v[60:63]
    ds_read_b64_tr_b16 v[72:73], v104 offset:28672
    ds_read_b64_tr_b16 v[74:75], v104 offset:29184
    s_waitcnt lgkmcnt(10)
    v_mfma_f32_16x16x32_bf16 v[32:35], v[28:31], v[76:79], v[32:35]
    ds_read_b64_tr_b16 v[76:77], v105 offset:28672
    ds_read_b64_tr_b16 v[78:79], v105 offset:29184
    v_mfma_f32_16x16x32_bf16 v[36:39], v[28:31], v[80:83], v[36:39]
    s_waitcnt lgkmcnt(8)
    v_mfma_f32_16x16x32_bf16 v[40:43], v[28:31], v[84:87], v[40:43]
    v_mfma_f32_16x16x32_bf16 v[44:47], v[28:31], v[12:15], v[44:47]
    s_waitcnt lgkmcnt(4)
    v_mfma_f32_16x16x32_bf16 v[48:51], v[28:31], v[64:67], v[48:51]
    v_mfma_f32_16x16x32_bf16 v[52:55], v[28:31], v[68:71], v[52:55]
    s_waitcnt lgkmcnt(0)
    v_mfma_f32_16x16x32_bf16 v[56:59], v[28:31], v[72:75], v[56:59]
    v_mfma_f32_16x16x32_bf16 v[60:63], v[28:31], v[76:79], v[60:63]
    s_cmp_eq_u32 s74, 0
    s_cbranch_scc0 L_g_xa
L_nl_t:
    ds_read_b64 v[10:11], v4 offset:2216
    s_waitcnt lgkmcnt(0)
    v_readfirstlane_b32 s40, v10
    v_readfirstlane_b32 s41, v11
    s_cmp_lg_u32 s40, 0
    s_cbranch_scc0 L_nl_t
    s_bfe_u32 s82, s40, 0x40001
    s_mul_i32 s82, s82, 5767168
    s_bfe_u32 s83, s40, 0x5000b
    s_mul_i32 s83, s83, 393216
    s_add_u32 s36, s36, s82
    s_addc_u32 s37, s37, 0
    v_add_u32 v119, s82, v119
    v_add_u32 v114, s83, v114
    v_add_u32 v109, s83, v109
    s_add_u32 s78, s78, s82
    s_add_u32 s78, s26, s78
    s_addc_u32 s79, s27, 0
    v_add_u32 v96, 32768, v96
    v_add_u32 v98, 32768, v98
    v_add_u32 v104, 32768, v104
    v_add_u32 v105, 32768, v105
    s_mov_b32 s74, 1
    v_mul_f32 v32, s80, v32
    v_mul_f32 v36, s80, v36
    v_mul_f32 v40, s80, v40
    v_mul_f32 v44, s80, v44
    v_cvt_pk_bf16_f32 v66, v48, v52
    v_cvt_pk_bf16_f32 v67, v56, v60
    v_cvt_pk_bf16_f32 v64, v32, v36
    v_cvt_pk_bf16_f32 v65, v40, v44
    global_store_dwordx4 v8, v[64:67], s[78:79] offset:0 sc1
    v_mul_f32 v33, s80, v33
    v_mul_f32 v37, s80, v37
    v_mul_f32 v41, s80, v41
    v_mul_f32 v45, s80, v45
    v_cvt_pk_bf16_f32 v70, v49, v53
    v_cvt_pk_bf16_f32 v71, v57, v61
    v_cvt_pk_bf16_f32 v68, v33, v37
    v_cvt_pk_bf16_f32 v69, v41, v45
    global_store_dwordx4 v8, v[68:71], s[78:79] offset:256 sc1
    v_mul_f32 v34, s80, v34
    v_mul_f32 v38, s80, v38
    v_mul_f32 v42, s80, v42
    v_mul_f32 v46, s80, v46
    v_cvt_pk_bf16_f32 v74, v50, v54
    v_cvt_pk_bf16_f32 v75, v58, v62
    v_cvt_pk_bf16_f32 v72, v34, v38
    v_cvt_pk_bf16_f32 v73, v42, v46
    s_lshl_b32 s31, s73, 4
    s_add_u32 s31, s31, 14
    s_cmp_lt_u32 s31, s1
    s_cselect_b32 exec_hi, -1, 0xffff
    global_store_dwordx4 v8, v[72:75], s[78:79] offset:512 sc1
    s_mov_b32 exec_hi, -1
    v_mul_f32 v35, s80, v35
    v_mul_f32 v39, s80, v39
    v_mul_f32 v43, s80, v43
    v_mul_f32 v47, s80, v47
    v_cvt_pk_bf16_f32 v78, v51, v55
    v_cvt_pk_bf16_f32 v79, v59, v63
    v_cvt_pk_bf16_f32 v76, v35, v39
    v_cvt_pk_bf16_f32 v77, v43, v47
    s_lshl_b32 s31, s73, 4
    s_add_u32 s31, s31, 15
    s_cmp_lt_u32 s31, s1
    s_cselect_b32 exec_hi, -1, 0xffff
    global_store_dwordx4 v8, v[76:79], s[78:79] offset:768 sc1
    s_mov_b32 exec_hi, -1
    s_mov_b64 exec, 1
    ds_add_u32 v4, v2 offset:2208
    s_mov_b64 exec, -1
    s_setprio 1
    s_mul_i32 s31, s30, 128
    s_add_u32 s31, s31, s29
    s_lshl_b32 s31, s31, 7
    s_add_u32 s31, s31, 226787328
    s_add_u32 s31, s31, s83
    v_mov_b32 v10, s31
    v_mov_b32 v12, s40
    v_mov_b32 v13, s41
    s_mov_b64 exec, 1
    s_waitcnt vmcnt(0)
    ds_add_rtn_u32 v11, v4, v2 offset:2180
    s_waitcnt lgkmcnt(0)
    v_readfirstlane_b32 s3, v11
    s_cmp_eq_u32 s3, 4
    s_cbranch_scc0 L_t_nf
L_lw_ta:
    ds_read_b32 v11, v4 offset:2176
    s_waitcnt lgkmcnt(0)
    v_readfirstlane_b32 s3, v11
    s_cmp_ge_u32 s3, 5
    s_cbranch_scc0 L_lw_ta
    global_store_dwordx2 v10, v[12:13], s[26:27] sc1
L_t_nf:
    s_mov_b64 exec, -1
L_lw_cd:
    ds_read_b32 v11, v4 offset:2200
    s_waitcnt lgkmcnt(0)
    v_readfirstlane_b32 s3, v11
    s_cmp_ge_u32 s3, 5
    s_cbranch_scc0 L_lw_cd
L_lw_g2:
    ds_read_b32 v11, v4 offset:2196
    s_waitcnt lgkmcnt(0)
    v_readfirstlane_b32 s3, v11
    s_cmp_ge_u32 s3, 131076
    s_cbranch_scc0 L_lw_g2
    s_branch L_gemm
L_g_xa:
    s_mul_i32 s31, s73, 12544
    s_add_u32 s31, s31, 3072
    v_mul_u32_u24 v10, 3136, v111
    v_add3_u32 v10, v10, v127, s31
    v_add_u32 v10, -2288, v10
    v_mov_b32 v11, 0xc2700000
    v_lshlrev_b32 v12, 2, v110
    v_lshl_add_u32 v12, v111, 10, v12
    v_add_u32 v12, s75, v12
    v_fma_f32 v32, v32, s80, v11
    v_fma_f32 v33, v33, s80, v11
    v_fma_f32 v34, v34, s80, v11
    v_fma_f32 v35, v35, s80, v11
    v_fma_f32 v36, v36, s80, v11
    v_fma_f32 v37, v37, s80, v11
    v_fma_f32 v38, v38, s80, v11
    v_fma_f32 v39, v39, s80, v11
    v_fma_f32 v40, v40, s80, v11
    v_fma_f32 v41, v41, s80, v11
    v_fma_f32 v42, v42, s80, v11
    v_fma_f32 v43, v43, s80, v11
    v_fma_f32 v44, v44, s80, v11
    v_fma_f32 v45, v45, s80, v11
    v_fma_f32 v46, v46, s80, v11
    v_fma_f32 v47, v47, s80, v11
    ds_write2_b32 v10, v32, v36 offset0:0 offset1:16
    ds_write2_b32 v10, v40, v44 offset0:32 offset1:48
    v_add_u32 v10, 784, v10
    ds_write2_b32 v10, v33, v37 offset0:0 offset1:16
    ds_write2_b32 v10, v41, v45 offset0:32 offset1:48
    v_add_u32 v10, 784, v10
    ds_write2_b32 v10, v34, v38 offset0:0 offset1:16
    ds_write2_b32 v10, v42, v46 offset0:32 offset1:48
    v_add_u32 v10, 784, v10
    ds_write2_b32 v10, v35, v39 offset0:0 offset1:16
    ds_write2_b32 v10, v43, v47 offset0:32 offset1:48
    v_mul_u32_u24 v11, 784, v110
    v_add_u32 v11, s31, v11
    ds_write_b64 v11, v[4:5] offset:768
    ds_write2_b32 v12, v48, v52 offset0:0 offset1:16
    ds_write2_b32 v12, v56, v60 offset0:32 offset1:48
    v_xor_b32 v13, 16, v12
    ds_write2_b32 v13, v49, v53 offset0:64 offset1:80
    ds_write2_b32 v13, v57, v61 offset0:96 offset1:112
    ds_write2_b32 v12, v50, v54 offset0:128 offset1:144
    ds_write2_b32 v12, v58, v62 offset0:160 offset1:176
    ds_write2_b32 v13, v51, v55 offset0:192 offset1:208
    ds_write2_b32 v13, v59, v63 offset0:224 offset1:240
    s_setprio 0
    s_waitcnt lgkmcnt(0)
    ds_read_b64 v[64:65], v93 offset:2304
    ds_read_b64 v[70:71], v93 offset:2304
    ds_read_b64 v[76:77], v93 offset:2304
    ds_read_b64 v[82:83], v93 offset:2304
    s_branch L_ranked
L_roleD:
    v_lshrrev_b32 v11, 3, v1
    v_and_b32 v12, 7, v1
    v_and_b32 v13, 2, v11
    v_xor_b32 v12, v12, v13
    v_lshlrev_b32 v12, 4, v12
    v_lshl_add_u32 v12, v11, 8, v12
    s_lshl_b32 s3, s30, 7
    v_add_u32 v12, s3, v12
    s_lshr_b32 s75, s2, 3
    s_and_b32 s31, s75, 1
    s_lshl_b32 s31, s31, 6
    v_xor_b32 v12, s31, v12
    v_xor_b32 v13, 64, v12
    s_mov_b32 s34, 32768
    s_waitcnt lgkmcnt(0)
    s_cmp_ge_u32 s28, 12
    s_cselect_b64 s[32:33], s[20:21], s[14:15]
    s_cmp_ge_u32 s28, 14
    s_cselect_b64 s[32:33], s[12:13], s[32:33]
    s_cbranch_scc0 L_d_b0
    s_cmp_eq_u32 s28, 15
    s_cbranch_scc1 L_d_15
    s_and_b32 s31, s75, 31
    s_lshl_b32 s31, s31, 10
    s_add_u32 s31, s31, s3
    v_and_b32 v16, 3, v1
    v_lshl_add_u32 v16, v16, 8, s31
    s_mov_b64 exec, 0xf
    global_load_dword v17, v16, s[14:15]
    s_mov_b64 exec, 0xf0
    global_load_dword v17, v16, s[20:21]
    s_mov_b64 exec, 0xf00
    global_load_dword v17, v16, s[12:13]
    s_mov_b64 exec, 0xf000
    global_load_dword v17, v16, s[18:19]
    s_mov_b64 exec, -1
    v_lshl_add_u32 v14, v1, 1, s3
    s_barrier
    global_load_ushort v20, v14, s[16:17] offset:0
    global_load_ushort v21, v14, s[16:17] offset:256
    global_load_ushort v22, v14, s[16:17] offset:512
    global_load_ushort v23, v14, s[16:17] offset:768
    s_call_b64 s[74:75], L_consts
    s_waitcnt vmcnt(0)
    v_lshlrev_b32 v20, 16, v20
    v_lshlrev_b32 v21, 16, v21
    v_lshlrev_b32 v22, 16, v22
    v_lshlrev_b32 v23, 16, v23
    v_mul_f32 v20, 0xbfb8aa3b, v20
    v_mul_f32 v21, 0xbfb8aa3b, v21
    v_mul_f32 v22, 0xbfb8aa3b, v22
    v_mul_f32 v23, 0xbfb8aa3b, v23
    v_cvt_pk_bf16_f32 v20, v20, v21
    v_cvt_pk_bf16_f32 v21, v22, v23
    ds_write_b64 v93, v[20:21] offset:2304
    s_branch L_d_late
L_d_15:
    s_mov_b64 s[32:33], s[18:19]
    s_cmp_eq_u32 s2, 0
    s_cbranch_scc0 L_d_nn
    s_or_b32 s31, s42, 1
    s_lshl_b32 s72, s43, 27
    v_mov_b32 v14, s31
    v_mov_b32 v15, s72
    s_mov_b64 exec, 1
    global_store_dwordx2 v4, v[14:15], s[24:25] sc1
    s_mov_b64 exec, -1
L_d_nn:
    s_barrier
    s_call_b64 s[74:75], L_consts
    s_branch L_lc_n15
L_lw_n15:
    s_sleep 1
L_lc_n15:
    ds_read_b32 v11, v4 offset:2188
    s_waitcnt lgkmcnt(0)
    v_readfirstlane_b32 s3, v11
    s_cmp_ge_u32 s3, 5
    s_cbranch_scc0 L_lw_n15
    s_load_dwordx2 s[40:41], s[24:25], 0
    s_waitcnt lgkmcnt(0)
    v_mov_b32 v14, s40
    v_mov_b32 v15, s41
    s_nop 0
    s_mov_b32 s15, 1048576
L_nn_w:
    v_readfirstlane_b32 s40, v14
    v_readfirstlane_b32 s41, v15
    s_cmp_lg_u32 s40, 0
    s_cbranch_scc1 L_nd_w
    s_sub_u32 s15, s15, 1
    s_cbranch_scc1 L_nd_w
    s_sleep 2
    global_load_dwordx2 v[14:15], v4, s[24:25] sc1
    s_waitcnt vmcnt(0)
    s_branch L_nn_w
L_nd_w:
    v_or_b32 v14, 1, v14
    ds_write_b64 v4, v[14:15] offset:2216
    s_bfe_u32 s3, s40, 0x40001
    s_mul_i32 s3, s3, 5767168
    s_mul_i32 s31, s30, 2592768
    s_lshl_b32 s72, s29, 8
    s_add_u32 s31, s31, s72
    s_add_u32 s31, s31, 2560000
    s_add_u32 s31, s31, s3
    v_mov_b32 v16, 0x50005000
    v_mov_b32 v17, 0x50005000
    v_mov_b32 v18, 0
    v_mov_b32 v19, 0
    v_lshl_add_u32 v20, v1, 4, s31
    s_mov_b64 exec, 0xffff
    global_store_dwordx4 v20, v[16:19], s[26:27] sc1
    s_mov_b64 exec, -1
L_d_late:
    s_lshl_b32 s31, s28, 14
    s_add_u32 s31, s31, -110336
    s_mov_b32 s72, 0
    s_mov_b32 s74, 2
    s_branch L_lc_gwa
L_lw_gwa:
    s_sleep 1
L_lc_gwa:
    ds_read_b32 v11, v4 offset:2200
    s_waitcnt lgkmcnt(0)
    v_readfirstlane_b32 s3, v11
    s_cmp_ge_u32 s3, 5
    s_cbranch_scc0 L_lw_gwa
    s_branch L_d_dma
L_d_b0:
    s_barrier
    s_call_b64 s[74:75], L_consts
    s_sub_u32 s31, s28, 10
    s_lshl_b32 s31, s31, 13
    s_add_u32 s31, s31, 86272
    s_and_b32 s72, s28, 1
    s_lshl_b32 s72, s72, 14
    s_mov_b32 s74, 1
L_lw_gwb:
    ds_read_b32 v11, v4 offset:2204
    s_waitcnt lgkmcnt(0)
    v_readfirstlane_b32 s3, v11
    s_cmp_ge_u32 s3, 5
    s_cbranch_scc0 L_lw_gwb
L_d_dma:
    s_lshr_b32 s75, s2, 3
    s_and_b32 s75, s75, 7
    s_lshl_b32 s73, s75, 10
    s_add_u32 m0, s31, s73
    s_lshl1_add_u32 s73, s73, s72
    buffer_load_dwordx4 v12, s[32:35], s73 offen lds
    s_add_u32 s75, s75, 1
    s_and_b32 s75, s75, 7
    s_lshl_b32 s73, s75, 10
    s_add_u32 m0, s31, s73
    s_lshl1_add_u32 s73, s73, s72
    buffer_load_dwordx4 v13, s[32:35], s73 offen lds
    s_add_u32 s75, s75, 1
    s_and_b32 s75, s75, 7
    s_lshl_b32 s73, s75, 10
    s_add_u32 m0, s31, s73
    s_lshl1_add_u32 s73, s73, s72
    buffer_load_dwordx4 v12, s[32:35], s73 offen lds
    s_add_u32 s75, s75, 1
    s_and_b32 s75, s75, 7
    s_lshl_b32 s73, s75, 10
    s_add_u32 m0, s31, s73
    s_lshl1_add_u32 s73, s73, s72
    buffer_load_dwordx4 v13, s[32:35], s73 offen lds
    s_add_u32 s75, s75, 1
    s_and_b32 s75, s75, 7
    s_lshl_b32 s73, s75, 10
    s_add_u32 m0, s31, s73
    s_lshl1_add_u32 s73, s73, s72
    buffer_load_dwordx4 v12, s[32:35], s73 offen lds
    s_add_u32 s75, s75, 1
    s_and_b32 s75, s75, 7
    s_lshl_b32 s73, s75, 10
    s_add_u32 m0, s31, s73
    s_lshl1_add_u32 s73, s73, s72
    buffer_load_dwordx4 v13, s[32:35], s73 offen lds
    s_add_u32 s75, s75, 1
    s_and_b32 s75, s75, 7
    s_lshl_b32 s73, s75, 10
    s_add_u32 m0, s31, s73
    s_lshl1_add_u32 s73, s73, s72
    buffer_load_dwordx4 v12, s[32:35], s73 offen lds
    s_add_u32 s75, s75, 1
    s_and_b32 s75, s75, 7
    s_lshl_b32 s73, s75, 10
    s_add_u32 m0, s31, s73
    s_lshl1_add_u32 s73, s73, s72
    buffer_load_dwordx4 v13, s[32:35], s73 offen lds
    s_add_u32 s31, s31, 8192
    s_add_u32 s72, s72, 16384
    s_sub_u32 s74, s74, 1
    s_cmp_lg_u32 s74, 0
    s_cbranch_scc1 L_d_dma
    s_mov_b64 exec, 1
    ds_add_u32 v4, v2 offset:2228
    s_mov_b64 exec, -1
    s_cmp_ge_u32 s28, 14
    s_cselect_b32 s3, 0x10000, 1
    v_mov_b32 v11, s3
    s_waitcnt vmcnt(0) lgkmcnt(0)
    s_mov_b64 exec, 1
    ds_add_u32 v4, v11 offset:2196
    s_mov_b64 exec, -1
L_poll0:
L_nl_q:
    ds_read_b64 v[56:57], v4 offset:2216
    s_waitcnt lgkmcnt(0)
    v_readfirstlane_b32 s40, v56
    v_readfirstlane_b32 s41, v57
    s_cmp_lg_u32 s40, 0
    s_cbranch_scc0 L_nl_q
    s_bfe_u32 s82, s40, 0x40001
    s_mul_i32 s82, s82, 5767168
    s_bfe_u32 s83, s40, 0x5000b
    s_mul_i32 s83, s83, 393216
    s_add_u32 s36, s36, s82
    s_addc_u32 s37, s37, 0
    v_add_u32 v119, s82, v119
    v_add_u32 v114, s83, v114
    v_add_u32 v109, s83, v109
L_poll1:
    s_mov_b32 s82, 0
    s_branch L_lc_pa
L_lw_pa:
    s_sleep 1
L_lc_pa:
    ds_read_b32 v56, v4 offset:2176
    s_waitcnt lgkmcnt(0)
    v_readfirstlane_b32 s3, v56
    s_cmp_ge_u32 s3, 5
    s_cbranch_scc0 L_lw_pa
    s_branch L_lc_pw
L_lw_pw:
    s_sleep 1
L_lc_pw:
    ds_read_b32 v56, v4 offset:2196
    s_waitcnt lgkmcnt(0)
    v_readfirstlane_b32 s3, v56
    s_cmp_ge_u32 s3, 131076
    s_cbranch_scc0 L_lw_pw
    ds_read_b64 v[64:65], v93 offset:2304
    ds_read_b64 v[70:71], v93 offset:2304
    ds_read_b64 v[76:77], v93 offset:2304
    ds_read_b64 v[82:83], v93 offset:2304
L_lw_pm:
    ds_read_b32 v56, v4 offset:2208
    s_waitcnt lgkmcnt(0)
    v_readfirstlane_b32 s3, v56
    s_cmp_ge_u32 s3, 5
    s_cbranch_scc0 L_lw_pm
    s_mov_b32 s15, 1048576
    s_mov_b64 exec, s[76:77]
    global_load_dwordx2 v[112:113], v114, s[26:27] sc1
    s_waitcnt vmcnt(0)
L_poll:
    s_andn2_b64 exec, s[76:77], s[42:43]
    v_and_b32 v56, 0xf8000000, v112
    v_cmp_eq_u32 vcc, s40, v113
    v_cmp_eq_u32 s[78:79], s41, v56
    s_mov_b64 exec, -1
    s_and_b64 s[78:79], s[78:79], vcc
    s_cbranch_scc0 L_repoll
    s_or_b64 s[42:43], s[42:43], s[78:79]
L_round:
    v_cndmask_b32 v60, 0, v112, s[78:79]
    s_or_b32 s31, s78, s79
    s_and_b32 s3, s31, 0x10001
    s_cbranch_scc0 L_lx0
    v_mov_b32_dpp v56, v60 row_newbcast:0 row_mask:0xf bank_mask:0xf
    v_and_b32 v57, 0x7ff, v56
    v_bfe_u32 v58, v56, 11, 11
    v_add_u32 v57, s16, v57
    v_subrev_u32 v58, s16, v58
    v_and_b32 v56, 0x7c00000, v56
    v_mad_u32_u24 v59, v57, 12, v115
    v_add_u32 v59, v56, v59
    v_cmp_lt_i32 vcc, v110, v58
    v_subrev_u32 v58, 16, v58
    v_cmp_lt_i32 s[80:81], v110, v58
    s_and_b64 exec, vcc, s[84:85]
    s_cbranch_execz L_ld0
    buffer_load_dwordx3 v[8:10], v59, s[68:71], 0 offen sc1
    s_or_b64 s[44:45], s[44:45], exec
    s_cmp_eq_u32 s17, 0
    s_cselect_b64 exec, s[80:81], 0
    s_cbranch_execz L_ld0
    buffer_load_dwordx3 v[32:34], v59, s[68:71], 0 offen offset:192 sc1
    s_or_b64 s[56:57], s[56:57], exec
    s_mov_b32 s82, 1
L_ld0:
    s_mov_b64 exec, -1
L_lx0:
    s_and_b32 s3, s31, 0x20002
    s_cbranch_scc0 L_lx1
    v_mov_b32_dpp v56, v60 row_newbcast:1 row_mask:0xf bank_mask:0xf
    v_and_b32 v57, 0x7ff, v56
    v_bfe_u32 v58, v56, 11, 11
    v_add_u32 v57, s16, v57
    v_subrev_u32 v58, s16, v58
    v_and_b32 v56, 0x7c00000, v56
    v_mad_u32_u24 v59, v57, 12, v115
    v_add_u32 v59, v56, v59
    v_cmp_lt_i32 vcc, v110, v58
    v_subrev_u32 v58, 16, v58
    v_cmp_lt_i32 s[80:81], v110, v58
    s_and_b64 exec, vcc, s[84:85]
    s_cbranch_execz L_ld1
    buffer_load_dwordx3 v[12:14], v59, s[68:71], s10 offen sc1
    s_or_b64 s[46:47], s[46:47], exec
    s_cmp_eq_u32 s17, 0
    s_cselect_b64 exec, s[80:81], 0
    s_cbranch_execz L_ld1
    buffer_load_dwordx3 v[36:38], v59, s[68:71], s10 offen offset:192 sc1
    s_or_b64 s[58:59], s[58:59], exec
    s_mov_b32 s82, 1
L_ld1:
    s_mov_b64 exec, -1
L_lx1:
    s_and_b32 s3, s31, 0x40004
    s_cbranch_scc0 L_lx2
    v_mov_b32_dpp v56, v60 row_newbcast:2 row_mask:0xf bank_mask:0xf
    v_and_b32 v57, 0x7ff, v56
    v_bfe_u32 v58, v56, 11, 11
    v_add_u32 v57, s16, v57
    v_subrev_u32 v58, s16, v58
    v_and_b32 v56, 0x7c00000, v56
    v_mad_u32_u24 v59, v57, 12, v115
    v_add_u32 v59, v56, v59
    v_cmp_lt_i32 vcc, v110, v58
    v_subrev_u32 v58, 16, v58
    v_cmp_lt_i32 s[80:81], v110, v58
    s_and_b64 exec, vcc, s[84:85]
    s_cbranch_execz L_ld2
    buffer_load_dwordx3 v[16:18], v59, s[68:71], s11 offen sc1
    s_or_b64 s[48:49], s[48:49], exec
    s_cmp_eq_u32 s17, 0
    s_cselect_b64 exec, s[80:81], 0
    s_cbranch_execz L_ld2
    buffer_load_dwordx3 v[40:42], v59, s[68:71], s11 offen offset:192 sc1
    s_or_b64 s[60:61], s[60:61], exec
    s_mov_b32 s82, 1
L_ld2:
    s_mov_b64 exec, -1
L_lx2:
    s_and_b32 s3, s31, 0x80008
    s_cbranch_scc0 L_lx3
    v_mov_b32_dpp v56, v60 row_newbcast:3 row_mask:0xf bank_mask:0xf
    v_and_b32 v57, 0x7ff, v56
    v_bfe_u32 v58, v56, 11, 11
    v_add_u32 v57, s16, v57
    v_subrev_u32 v58, s16, v58
    v_and_b32 v56, 0x7c00000, v56
    v_mad_u32_u24 v59, v57, 12, v115
    v_add_u32 v59, v56, v59
    v_cmp_lt_i32 vcc, v110, v58
    v_subrev_u32 v58, 16, v58
    v_cmp_lt_i32 s[80:81], v110, v58
    s_and_b64 exec, vcc, s[84:85]
    s_cbranch_execz L_ld3
    buffer_load_dwordx3 v[20:22], v59, s[68:71], s12 offen sc1
    s_or_b64 s[50:51], s[50:51], exec
    s_cmp_eq_u32 s17, 0
    s_cselect_b64 exec, s[80:81], 0
    s_cbranch_execz L_ld3
    buffer_load_dwordx3 v[44:46], v59, s[68:71], s12 offen offset:192 sc1
    s_or_b64 s[62:63], s[62:63], exec
    s_mov_b32 s82, 1
L_ld3:
    s_mov_b64 exec, -1
L_lx3:
    s_and_b32 s3, s31, 0x100010
    s_cbranch_scc0 L_lx4
    v_mov_b32_dpp v56, v60 row_newbcast:4 row_mask:0xf bank_mask:0xf
    v_and_b32 v57, 0x7ff, v56
    v_bfe_u32 v58, v56, 11, 11
    v_add_u32 v57, s16, v57
    v_subrev_u32 v58, s16, v58
    v_and_b32 v56, 0x7c00000, v56
    v_mad_u32_u24 v59, v57, 12, v115
    v_add_u32 v59, v56, v59
    v_cmp_lt_i32 vcc, v110, v58
    v_subrev_u32 v58, 16, v58
    v_cmp_lt_i32 s[80:81], v110, v58
    s_and_b64 exec, vcc, s[84:85]
    s_cbranch_execz L_ld4
    buffer_load_dwordx3 v[24:26], v59, s[68:71], s13 offen sc1
    s_or_b64 s[52:53], s[52:53], exec
    s_cmp_eq_u32 s17, 0
    s_cselect_b64 exec, s[80:81], 0
    s_cbranch_execz L_ld4
    buffer_load_dwordx3 v[48:50], v59, s[68:71], s13 offen offset:192 sc1
    s_or_b64 s[64:65], s[64:65], exec
    s_mov_b32 s82, 1
L_ld4:
    s_mov_b64 exec, -1
L_lx4:
    s_and_b32 s3, s31, 0x200020
    s_cbranch_scc0 L_lx5
    v_mov_b32_dpp v56, v60 row_newbcast:5 row_mask:0xf bank_mask:0xf
    v_and_b32 v57, 0x7ff, v56
    v_bfe_u32 v58, v56, 11, 11
    v_add_u32 v57, s16, v57
    v_subrev_u32 v58, s16, v58
    v_and_b32 v56, 0x7c00000, v56
    v_mad_u32_u24 v59, v57, 12, v115
    v_add_u32 v59, v56, v59
    v_cmp_lt_i32 vcc, v110, v58
    v_subrev_u32 v58, 16, v58
    v_cmp_lt_i32 s[80:81], v110, v58
    s_and_b64 exec, vcc, s[84:85]
    s_cbranch_execz L_ld5
    buffer_load_dwordx3 v[28:30], v59, s[68:71], s14 offen sc1
    s_or_b64 s[54:55], s[54:55], exec
    s_cmp_eq_u32 s17, 0
    s_cselect_b64 exec, s[80:81], 0
    s_cbranch_execz L_ld5
    buffer_load_dwordx3 v[52:54], v59, s[68:71], s14 offen offset:192 sc1
    s_or_b64 s[66:67], s[66:67], exec
    s_mov_b32 s82, 1
L_ld5:
    s_mov_b64 exec, -1
L_lx5:
L_repoll:
    s_andn2_b64 exec, s[76:77], s[42:43]
    s_cbranch_execz L_polled
    s_sub_u32 s15, s15, 1
    s_cbranch_scc1 L_giveup
    s_sleep 8
    global_load_dwordx2 v[112:113], v114, s[26:27] sc1
    s_waitcnt vmcnt(0)
    s_branch L_poll
L_polled:
    s_mov_b64 exec, s[76:77]
    v_bfe_u32 v56, v112, 11, 11
    ds_max_u32 v4, v56 offset:2184
    s_waitcnt vmcnt(0)
    s_mov_b64 exec, s[6:7]
    s_cbranch_execz L_nof2
    global_load_dwordx2 v[88:89], v109, s[26:27] sc1
L_nof2:
    s_mov_b64 exec, s[44:45]
    v_lshrrev_b32 v66, 14, v10
    ds_add_rtn_u32 v11, v66, v3 offset:1024
    s_mov_b64 exec, s[46:47]
    v_lshrrev_b32 v67, 14, v14
    ds_add_rtn_u32 v15, v67, v3 offset:1024
    s_mov_b64 exec, s[48:49]
    v_lshrrev_b32 v68, 14, v18
    ds_add_rtn_u32 v19, v68, v3 offset:1024
    s_mov_b64 exec, s[50:51]
    v_lshrrev_b32 v69, 14, v22
    ds_add_rtn_u32 v23, v69, v3 offset:1024
    s_mov_b64 exec, s[52:53]
    v_lshrrev_b32 v72, 14, v26
    ds_add_rtn_u32 v27, v72, v3 offset:1024
    s_mov_b64 exec, s[54:55]
    v_lshrrev_b32 v73, 14, v30
    ds_add_rtn_u32 v31, v73, v3 offset:1024
    s_cmp_eq_u32 s82, 0
    s_cbranch_scc1 L_rkx
    s_mov_b64 exec, s[56:57]
    s_cbranch_execz L_rk6
    v_lshrrev_b32 v74, 14, v34
    ds_add_rtn_u32 v35, v74, v3 offset:1024
L_rk6:
    s_mov_b64 exec, s[58:59]
    s_cbranch_execz L_rk7
    v_lshrrev_b32 v75, 14, v38
    ds_add_rtn_u32 v39, v75, v3 offset:1024
L_rk7:
    s_mov_b64 exec, s[60:61]
    s_cbranch_execz L_rk8
    v_lshrrev_b32 v78, 14, v42
    ds_add_rtn_u32 v43, v78, v3 offset:1024
L_rk8:
    s_mov_b64 exec, s[62:63]
    s_cbranch_execz L_rk9
    v_lshrrev_b32 v79, 14, v46
    ds_add_rtn_u32 v47, v79, v3 offset:1024
L_rk9:
    s_mov_b64 exec, s[64:65]
    s_cbranch_execz L_rk10
    v_lshrrev_b32 v80, 14, v50
    ds_add_rtn_u32 v51, v80, v3 offset:1024
L_rk10:
    s_mov_b64 exec, s[66:67]
    s_cbranch_execz L_rk11
    v_lshrrev_b32 v81, 14, v54
    ds_add_rtn_u32 v55, v81, v3 offset:1024
L_rk11:
L_rkx:
L_ranked:
    s_mov_b64 exec, -1
    s_waitcnt lgkmcnt(0)
    s_barrier
    s_lshl_b32 s75, s28, 2
    v_mov_b32 v118, s75
    s_sub_u32 s3, s28, 5
    s_cmp_lt_u32 s3, 5
    s_cbranch_scc1 L_tscan
    s_waitcnt vmcnt(0)
    s_mov_b64 exec, s[6:7]
    s_cbranch_execz L_f2c
    v_cmp_ne_u32 vcc, s40, v88
    v_cmp_ne_u32 s[78:79], s41, v89
    s_or_b64 vcc, vcc, s[78:79]
    s_cbranch_scc1 L_f2c
    s_mov_b64 exec, s[8:9]
    global_load_dword v117, v119, s[26:27] sc1
    s_mov_b64 s[6:7], 0
L_f2c:
    s_mov_b64 exec, -1
    s_setprio 2
    s_barrier
    ds_read_b32 v116, v118 offset:2816
    s_mov_b64 exec, s[44:45]
    ds_read_b32 v66, v66 offset:1536
    s_mov_b64 exec, s[46:47]
    ds_read_b32 v67, v67 offset:1536
    s_mov_b64 exec, s[48:49]
    ds_read_b32 v68, v68 offset:1536
    s_mov_b64 exec, s[50:51]
    ds_read_b32 v69, v69 offset:1536
    s_mov_b64 exec, s[52:53]
    ds_read_b32 v72, v72 offset:1536
    s_mov_b64 exec, s[54:55]
    ds_read_b32 v73, v73 offset:1536
    s_cmp_eq_u32 s82, 0
    s_cbranch_scc1 L_srx
    s_mov_b64 exec, s[56:57]
    s_cbranch_execz L_sr6
    ds_read_b32 v74, v74 offset:1536
L_sr6:
    s_mov_b64 exec, s[58:59]
    s_cbranch_execz L_sr7
    ds_read_b32 v75, v75 offset:1536
L_sr7:
    s_mov_b64 exec, s[60:61]
    s_cbranch_execz L_sr8
    ds_read_b32 v78, v78 offset:1536
L_sr8:
    s_mov_b64 exec, s[62:63]
    s_cbranch_execz L_sr9
    ds_read_b32 v79, v79 offset:1536
L_sr9:
    s_mov_b64 exec, s[64:65]
    s_cbranch_execz L_sr10
    ds_read_b32 v80, v80 offset:1536
L_sr10:
    s_mov_b64 exec, s[66:67]
    s_cbranch_execz L_sr11
    ds_read_b32 v81, v81 offset:1536
L_sr11:
L_srx:
    s_setprio 1
    s_mov_b64 exec, -1
    s_waitcnt lgkmcnt(0)
    v_readfirstlane_b32 s21, v116
    s_bitcmp1_b32 s21, 31
    s_cbranch_scc1 L_goslow
    s_mov_b64 exec, s[44:45]
    v_add_u32 v66, v66, v11
    v_lshrrev_b32 v11, 1, v66
    ds_write_b64 v66, v[8:9]
    ds_write_b32 v11, v10 offset:36352
    s_mov_b64 exec, s[46:47]
    v_add_u32 v67, v67, v15
    v_lshrrev_b32 v15, 1, v67
    ds_write_b64 v67, v[12:13]
    ds_write_b32 v15, v14 offset:36352
    s_mov_b64 exec, s[48:49]
    v_add_u32 v68, v68, v19
    v_lshrrev_b32 v19, 1, v68
    ds_write_b64 v68, v[16:17]
    ds_write_b32 v19, v18 offset:36352
    s_mov_b64 exec, s[50:51]
    v_add_u32 v69, v69, v23
    v_lshrrev_b32 v23, 1, v69
    ds_write_b64 v69, v[20:21]
    ds_write_b32 v23, v22 offset:36352
    s_mov_b64 exec, s[52:53]
    v_add_u32 v72, v72, v27
    v_lshrrev_b32 v27, 1, v72
    ds_write_b64 v72, v[24:25]
    ds_write_b32 v27, v26 offset:36352
    s_mov_b64 exec, s[54:55]
    v_add_u32 v73, v73, v31
    v_lshrrev_b32 v31, 1, v73
    ds_write_b64 v73, v[28:29]
    ds_write_b32 v31, v30 offset:36352
    s_cmp_eq_u32 s82, 0
    s_cbranch_scc1 L_swx
    s_mov_b64 exec, s[56:57]
    s_cbranch_execz L_sw6
    v_add_u32 v74, v74, v35
    v_lshrrev_b32 v35, 1, v74
    ds_write_b64 v74, v[32:33]
    ds_write_b32 v35, v34 offset:36352
L_sw6:
    s_mov_b64 exec, s[58:59]
    s_cbranch_execz L_sw7
    v_add_u32 v75, v75, v39
    v_lshrrev_b32 v39, 1, v75
    ds_write_b64 v75, v[36:37]
    ds_write_b32 v39, v38 offset:36352
L_sw7:
    s_mov_b64 exec, s[60:61]
    s_cbranch_execz L_sw8
    v_add_u32 v78, v78, v43
    v_lshrrev_b32 v43, 1, v78
    ds_write_b64 v78, v[40:41]
    ds_write_b32 v43, v42 offset:36352
L_sw8:
    s_mov_b64 exec, s[62:63]
    s_cbranch_execz L_sw9
    v_add_u32 v79, v79, v47
    v_lshrrev_b32 v47, 1, v79
    ds_write_b64 v79, v[44:45]
    ds_write_b32 v47, v46 offset:36352
L_sw9:
    s_mov_b64 exec, s[64:65]
    s_cbranch_execz L_sw10
    v_add_u32 v80, v80, v51
    v_lshrrev_b32 v51, 1, v80
    ds_write_b64 v80, v[48:49]
    ds_write_b32 v51, v50 offset:36352
L_sw10:
    s_mov_b64 exec, s[66:67]
    s_cbranch_execz L_sw11
    v_add_u32 v81, v81, v55
    v_lshrrev_b32 v55, 1, v81
    ds_write_b64 v81, v[52:53]
    ds_write_b32 v55, v54 offset:36352
L_sw11:
L_swx:
    s_mov_b64 exec, -1
    s_setprio 0
    s_branch L_geom
L_tscan:
    s_setprio 3
    ds_read_b64 v[56:57], v93 offset:1024
    ds_read_b32 v116, v4 offset:2184
    s_lshr_b32 s31, s1, 1
    s_sub_u32 s72, s1, s31
    s_bfm_b64 vcc, s72, 0
    s_bfm_b64 s[80:81], s31, 0
    s_waitcnt lgkmcnt(1)
    v_add_u32 v58, 8, v56
    v_add_u32 v59, 8, v57
    v_and_b32 v58, -16, v58
    v_and_b32 v59, -16, v59
    v_max_u32 v58, 32, v58
    v_max_u32 v59, 32, v59
    v_cndmask_b32 v58, 0, v58, vcc
    v_cndmask_b32 v59, 0, v59, s[80:81]
    v_add_u32 v60, v58, v59
    v_subrev_u32 v61, 99840, v60
    s_nop 1
    v_add_u32_dpp v60, v60, v60 row_shr:1 row_mask:0xf bank_mask:0xf
    s_nop 1
    v_add_u32_dpp v60, v60, v60 row_shr:2 row_mask:0xf bank_mask:0xf
    s_nop 1
    v_add_u32_dpp v60, v60, v60 row_shr:4 row_mask:0xf bank_mask:0xf
    s_nop 1
    v_add_u32_dpp v60, v60, v60 row_shr:8 row_mask:0xf bank_mask:0xf
    s_nop 1
    v_add_u32_dpp v60, v60, v60 row_bcast:15 row_mask:0xa bank_mask:0xf
    s_nop 1
    v_add_u32_dpp v60, v60, v60 row_bcast:31 row_mask:0xc bank_mask:0xf
    v_sub_u32 v62, v60, v61
    v_readlane_b32 s19, v60, 63
    v_add_u32 v63, v58, v62
    ds_write_b64 v93, v[62:63] offset:1536
    s_lshr_b32 s19, s19, 4
    s_add_u32 s31, s19, 3
    s_lshr_b32 s72, s31, 6
    s_bfe_u32 s73, s31, 0x40002
    v_min_u32 v8, s73, v1
    v_mad_u32_u24 v8, v1, s72, v8
    v_cmp_gt_u32 vcc, s73, v1
    v_mov_b32 v9, s72
    s_waitcnt lgkmcnt(1)
    v_readfirstlane_b32 s18, v116
    v_addc_co_u32 v9, vcc, 0, v9, vcc
    s_cmp_gt_u32 s19, 1660
    s_cselect_b32 s72, 33, s18
    s_cmp_gt_u32 s72, 32
    s_cselect_b32 s72, 1, 0
    s_cmp_gt_u32 s72, s17
    s_cselect_b32 s72, 0x80000000, 0
    v_lshlrev_b32 v8, 2, v8
    v_lshl_or_b32 v8, v9, 16, v8
    v_or_b32 v8, s72, v8
    v_lshrrev_b32 v9, 1, v93
    s_mov_b64 exec, 0xffff
    ds_write_b32 v9, v8 offset:2816
    s_mov_b64 exec, -1
    v_readlane_b32 s21, v8, s28
    s_waitcnt lgkmcnt(0)
    s_barrier
    s_setprio 0
    s_bitcmp1_b32 s21, 31
    s_cbranch_scc1 L_goslow
    s_add_u32 s74, s29, 10000
    s_cmp_eq_u32 s3, 4
    s_cbranch_scc1 L_padtail
    s_lshl_b32 s3, s3, 3
    v_add_u32 v8, s3, v56
    v_add_u32 v9, v8, v62
    v_cmp_lt_u32 vcc, v8, v58
    v_lshl_add_u32 v10, v1, 1, 0
    v_lshl_or_b32 v10, v10, 16, s74
    v_lshrrev_b32 v11, 1, v9
    s_mov_b64 exec, vcc
    ds_write_b32 v11, v10 offset:36352
    ds_write_b64 v9, v[4:5]
    s_mov_b64 exec, -1
    v_add_u32 v8, s3, v57
    v_add_u32 v9, v8, v63
    v_cmp_lt_u32 vcc, v8, v59
    v_lshl_add_u32 v10, v1, 1, 1
    v_lshl_or_b32 v10, v10, 16, s74
    v_lshrrev_b32 v11, 1, v9
    s_mov_b64 exec, vcc
    ds_write_b32 v11, v10 offset:36352
    ds_write_b64 v9, v[4:5]
    s_mov_b64 exec, -1
    s_branch L_geom
L_padtail:
    s_add_u32 s31, s19, 3
    s_and_b32 s31, s31, -4
    s_lshl_b32 s31, s31, 1
    s_lshl_b32 s72, s19, 1
    v_add_u32 v8, s72, v1
    v_cmp_eq_u32 vcc, s31, v8
    s_sub_u32 s72, s1, 1
    v_mov_b32 v10, s72
    v_mov_b32 v11, 255
    v_cndmask_b32 v10, v10, v11, vcc
    v_cmp_ge_u32 vcc, s31, v8
    v_lshl_or_b32 v10, v10, 16, s74
    v_lshlrev_b32 v9, 3, v8
    v_add_u32 v9, 99840, v9
    v_lshrrev_b32 v11, 1, v9
    s_mov_b64 exec, vcc
    ds_write_b32 v11, v10 offset:36352
    ds_write_b64 v9, v[4:5]
    s_mov_b64 exec, -1
L_geom:
    s_lshr_b32 s20, s21, 16
    s_and_b32 s21, s21, 0xffff
    s_lshl_b32 s74, s21, 3
    s_add_u32 s73, s74, 86272
    s_lshl_b32 s75, s20, 3
    v_mov_b32 v56, s73
    v_mad_u32_u24 v104, v111, s75, v56
    v_mov_b32 v9, v97
    v_mov_b32 v11, v97
    s_cmp_eq_u64 s[6:7], 0
    s_cbranch_scc0 L_f2
L_f2_done:
    s_mov_b64 exec, -1
    s_cmp_lt_u32 s28, 10
    s_cbranch_scc0 L_nox
    s_mov_b64 exec, s[34:35]
    global_load_dwordx4 v[116:119], v120, s[4:5]
    s_mov_b64 exec, -1
L_nox:
    s_waitcnt lgkmcnt(0)
    s_barrier
    s_setprio 3
    ds_read_u16 v96, v104 offset:0
    ds_read_u16 v98, v104 offset:4
    ds_read_u16 v8, v104 offset:8
    ds_read_u16 v10, v104 offset:12
    ds_read_u16 v12, v104 offset:2
    s_sub_u32 s31, s20, 1
    s_bfm_b64 s[6:7], s31, 0
    s_mov_b32 s72, 784
    s_waitcnt lgkmcnt(3)
    buffer_load_dwordx4 v[66:69], v[96:97], s[36:39], 0 idxen offen sc1
    buffer_load_dwordx4 v[72:75], v[98:99], s[36:39], 0 idxen offen sc1
    v_lshrrev_b32 v60, 5, v1
    v_mad_u32_u24 v60, v60, s75, v56
    v_and_b32 v61, 0xf8, v93
    v_add_u32 v60, v60, v61
    s_lshl_b32 s75, s20, 4
    v_add_u32 v61, s75, v60
    s_lshl1_add_u32 s73, s74, 99840
    v_bfe_u32 v57, v1, 2, 2
    v_mov_b32 v58, s73
    v_mad_u32_u24 v57, v57, s75, v58
    v_cmp_ne_u32 vcc, 0, v106
    v_mov_b32 v15, v93
    v_mov_b32 v58, 2056
    v_cndmask_b32 v105, v58, v57, vcc
    v_mov_b32 v40, 1.0
    v_mov_b32 v41, 1.0
    v_mov_b32 v42, 1.0
    v_mov_b32 v43, 1.0
    v_mov_b64 v[44:45], 0
    v_mov_b64 v[46:47], 0
    v_mov_b64 v[48:49], 0
    v_mov_b64 v[50:51], 0
    v_mov_b64 v[52:53], 0
    v_mov_b64 v[54:55], 0
    v_mov_b64 v[56:57], 0
    v_mov_b64 v[58:59], 0
    s_waitcnt lgkmcnt(0)
    buffer_load_dwordx4 v[78:81], v[8:9], s[36:39], 0 idxen offen sc1
    buffer_load_dwordx4 v[84:87], v[10:11], s[36:39], 0 idxen offen sc1
    ds_read_u16 v16, v60 offset:2
    ds_read_u16 v17, v60 offset:10
    ds_read_u16 v18, v61 offset:2
    ds_read_u16 v19, v61 offset:10
    ds_read_b64 v[88:89], v105 offset:0
    ds_read_b64 v[92:93], v105 offset:8
    s_cmp_eq_u32 s17, 0
    s_cbranch_scc1 L_nozero
    ds_write_b64 v15, v[4:5] offset:1024
L_nozero:
    v_mad_u32_u24 v107, v12, s72, v127
    ds_read2_b32 v[60:61], v107 offset0:196 offset1:212
    ds_read2_b32 v[62:63], v107 offset0:228 offset1:244
    ds_read_u16 v96, v104 offset:16
    ds_read_u16 v98, v104 offset:20
    s_waitcnt lgkmcnt(6)
    s_mov_b32 s3, 0
    v_cmp_ne_u32 vcc, v18, v19
    s_bitcmp1_b32 vcc_hi, s31
    s_addc_u32 s3, s3, s3
    s_and_b32 s51, vcc_hi, s6
    s_lshl_b32 s50, s51, 2
    s_bitcmp1_b32 vcc_lo, s31
    s_addc_u32 s3, s3, s3
    s_and_b32 s49, vcc_lo, s6
    s_lshl_b32 s48, s49, 2
    v_cmp_ne_u32 vcc, v16, v17
    s_bitcmp1_b32 vcc_hi, s31
    s_addc_u32 s3, s3, s3
    s_and_b32 s47, vcc_hi, s6
    s_lshl_b32 s46, s47, 2
    s_bitcmp1_b32 vcc_lo, s31
    s_addc_u32 s3, s3, s3
    s_and_b32 s45, vcc_lo, s6
    s_lshl_b32 s44, s45, 2
    s_or_b64 s[52:53], s[44:45], s[46:47]
    s_or_b64 s[78:79], s[48:49], s[50:51]
    s_or_b64 s[52:53], s[52:53], s[78:79]
    s_or_b32 s78, s52, s53
    s_lshr_b32 s78, s78, 1
    s_bitset1_b32 s78, s31
    s_mul_i32 s54, s20, 8
    s_lshr_b32 s54, s54, 4
    s_mul_i32 s55, s20, 13
    s_lshr_b32 s55, s55, 4
    s_mul_i32 s56, s20, 15
    s_lshr_b32 s56, s56, 4
    s_sub_u32 s72, s20, 4
    s_max_i32 s72, s72, 0
    s_bitset1_b32 s78, s72
    s_brev_b32 s82, s78
    s_sub_u32 s83, s20, 32
    s_cmp_gt_u32 s20, 3
    s_cselect_b64 vcc, 1, 0
    s_waitcnt vmcnt(2) lgkmcnt(0)
    v_mfma_f32_16x16x32_bf16 v[8:11], v[88:91], v[64:67], v[60:63]
    v_mfma_f32_16x16x32_bf16 v[12:15], v[92:95], v[70:73], v[60:63]
    v_mfma_f32_4x4x4_16b_bf16 v[24:27], v[100:101], v[68:69], 0
    v_mfma_f32_4x4x4_16b_bf16 v[28:31], v[100:101], v[74:75], 0
    buffer_load_dwordx4 v[66:69], v[96:97], s[36:39], 0 idxen offen sc1
    buffer_load_dwordx4 v[72:75], v[98:99], s[36:39], 0 idxen offen sc1
    ds_read_b64 v[88:89], v105 offset:16
    ds_read_b64 v[92:93], v105 offset:24
    ds_read_u16 v96, v104 offset:24
    ds_read_u16 v98, v104 offset:28
    s_bitcmp1_b32 s53, 0
    s_cbranch_scc0 L_loop
    s_bitcmp1_b32 s45, 0
    s_cselect_b32 s72, 0xffff, 0
    s_bitcmp1_b32 s47, 0
    s_cselect_b32 s73, 0xffff0000, 0
    s_or_b32 exec_lo, s72, s73
    s_bitcmp1_b32 s49, 0
    s_cselect_b32 s72, 0xffff, 0
    s_bitcmp1_b32 s51, 0
    s_cselect_b32 s73, 0xffff0000, 0
    s_or_b32 exec_hi, s72, s73
    v_add_u32 v107, 784, v107
    ds_read2_b32 v[60:61], v107 offset0:196 offset1:212
    ds_read2_b32 v[62:63], v107 offset0:228 offset1:244
    s_mov_b64 exec, -1
.p2align 3
L_loop:
    v_exp_f32_e64 v8, v8 clamp
    s_waitcnt vmcnt(2) lgkmcnt(0)
    s_add_u32 s82, s82, s82
    v_mfma_f32_16x16x32_bf16 v[16:19], v[88:91], v[76:79], v[60:63]
    v_exp_f32_e64 v9, v9 clamp
    v_exp_f32_e64 v10, v10 clamp
    v_mfma_f32_16x16x32_bf16 v[20:23], v[92:95], v[82:85], v[60:63]
    v_exp_f32_e64 v11, v11 clamp
    v_exp_f32_e64 v12, v12 clamp
    v_mfma_f32_4x4x4_16b_bf16 v[32:35], v[100:101], v[80:81], 0
    v_exp_f32_e64 v13, v13 clamp
    v_mfma_f32_4x4x4_16b_bf16 v[8:11], v[100:101], v[102:103], v[8:11]
    v_exp_f32_e64 v14, v14 clamp
    v_mfma_f32_4x4x4_16b_bf16 v[36:39], v[100:101], v[86:87], 0
    v_exp_f32_e64 v15, v15 clamp
    v_rcp_f32_e32 v40, v40
    v_rcp_f32_e32 v41, v41
    v_mfma_f32_4x4x4_16b_bf16 v[12:15], v[100:101], v[102:103], v[12:15]
    v_rcp_f32_e64 v42, v42
    v_rcp_f32_e32 v43, v43
    s_cbranch_vccz L_skipg0
    buffer_load_dwordx4 v[78:81], v[96:97], s[36:39], 0 idxen offen sc1
    buffer_load_dwordx4 v[84:87], v[98:99], s[36:39], 0 idxen offen sc1
L_backg0:
    ds_read_b64 v[88:89], v105 offset:32
    ds_read_b64 v[92:93], v105 offset:40
    ds_read_u16 v96, v104 offset:32
    ds_read_u16 v98, v104 offset:36
    v_pk_fma_f32 v[52:53], v[44:45], v[40:41], v[52:53]
    v_pk_fma_f32 v[54:55], v[46:47], v[42:43], v[54:55]
    v_pk_fma_f32 v[56:57], v[48:49], v[40:41], v[56:57]
    v_pk_fma_f32 v[58:59], v[50:51], v[42:43], v[58:59]
    v_pk_mul_f32 v[40:41], v[8:9], v[12:13]
    v_pk_mul_f32 v[42:43], v[10:11], v[14:15]
    v_pk_mul_f32 v[48:49], v[24:25], v[12:13]
    v_pk_mul_f32 v[50:51], v[26:27], v[14:15]
    v_pk_add_f32 v[44:45], v[8:9], v[12:13]
    v_pk_add_f32 v[46:47], v[10:11], v[14:15]
    v_pk_fma_f32 v[48:49], v[28:29], v[8:9], v[48:49]
    v_pk_fma_f32 v[50:51], v[30:31], v[10:11], v[50:51]
    s_cbranch_scc1 L_h0
L_r0:
    v_add_u32 v104, 16, v104
    v_exp_f32_e64 v16, v16 clamp
    s_waitcnt vmcnt(2) lgkmcnt(0)
    s_add_u32 s82, s82, s82
    v_mfma_f32_16x16x32_bf16 v[8:11], v[88:91], v[64:67], v[60:63]
    v_exp_f32_e64 v17, v17 clamp
    v_exp_f32_e64 v18, v18 clamp
    v_mfma_f32_16x16x32_bf16 v[12:15], v[92:95], v[70:73], v[60:63]
    v_exp_f32_e64 v19, v19 clamp
    v_exp_f32_e64 v20, v20 clamp
    v_mfma_f32_4x4x4_16b_bf16 v[24:27], v[100:101], v[68:69], 0
    v_exp_f32_e64 v21, v21 clamp
    v_mfma_f32_4x4x4_16b_bf16 v[16:19], v[100:101], v[102:103], v[16:19]
    v_exp_f32_e64 v22, v22 clamp
    v_mfma_f32_4x4x4_16b_bf16 v[28:31], v[100:101], v[74:75], 0
    v_exp_f32_e64 v23, v23 clamp
    v_rcp_f32_e32 v40, v40
    v_rcp_f32_e32 v41, v41
    v_mfma_f32_4x4x4_16b_bf16 v[20:23], v[100:101], v[102:103], v[20:23]
    v_rcp_f32_e64 v42, v42
    v_rcp_f32_e32 v43, v43
    s_cbranch_vccz L_skipg1
    buffer_load_dwordx4 v[66:69], v[96:97], s[36:39], 0 idxen offen sc1
    buffer_load_dwordx4 v[72:75], v[98:99], s[36:39], 0 idxen offen sc1
L_backg1:
    ds_read_b64 v[88:89], v105 offset:48
    ds_read_b64 v[92:93], v105 offset:56
    ds_read_u16 v96, v104 offset:24
    ds_read_u16 v98, v104 offset:28
    v_pk_fma_f32 v[52:53], v[44:45], v[40:41], v[52:53]
    v_pk_fma_f32 v[54:55], v[46:47], v[42:43], v[54:55]
    v_pk_fma_f32 v[56:57], v[48:49], v[40:41], v[56:57]
    v_pk_fma_f32 v[58:59], v[50:51], v[42:43], v[58:59]
    v_pk_mul_f32 v[40:41], v[16:17], v[20:21]
    v_pk_mul_f32 v[42:43], v[18:19], v[22:23]
    v_pk_mul_f32 v[48:49], v[32:33], v[20:21]
    v_pk_mul_f32 v[50:51], v[34:35], v[22:23]
    v_pk_add_f32 v[44:45], v[16:17], v[20:21]
    v_pk_add_f32 v[46:47], v[18:19], v[22:23]
    v_pk_fma_f32 v[48:49], v[36:37], v[16:17], v[48:49]
    v_pk_fma_f32 v[50:51], v[38:39], v[18:19], v[50:51]
    v_add_u32 v105, v106, v105
    s_cbranch_scc0 L_loop
    s_ff1_i32_b32 s31, s82
    s_cmp_eq_u32 s82, 0
    s_cselect_b32 s31, 32, s31
    s_add_u32 s31, s31, s83
    s_add_u32 s73, s31, 3
    s_cmp_gt_u32 s20, s73
    s_cselect_b64 vcc, 1, 0
    s_bitcmp1_b32 s52, s31
    s_cbranch_scc0 L_nofl1
    s_bitcmp1_b32 s44, s31
    s_cselect_b32 s72, 0xffff, 0
    s_bitcmp1_b32 s46, s31
    s_cselect_b32 s73, 0xffff0000, 0
    s_or_b32 exec_lo, s72, s73
    s_bitcmp1_b32 s48, s31
    s_cselect_b32 s72, 0xffff, 0
    s_bitcmp1_b32 s50, s31
    s_cselect_b32 s73, 0xffff0000, 0
    s_or_b32 exec_hi, s72, s73
    ds_write2_b32 v107, v52, v53 offset0:64 offset1:80
    ds_write2_b32 v107, v54, v55 offset0:96 offset1:112
    ds_write2_b32 v107, v56, v57 offset0:128 offset1:144
    ds_write2_b32 v107, v58, v59 offset0:160 offset1:176
    ds_read_b128 v[52:55], v108
    ds_read_b128 v[56:59], v108
L_nofl1:
    s_bitcmp1_b32 s53, s31
    s_cbranch_scc0 L_nosw1
    s_bitcmp1_b32 s45, s31
    s_cselect_b32 s72, 0xffff, 0
    s_bitcmp1_b32 s47, s31
    s_cselect_b32 s73, 0xffff0000, 0
    s_or_b32 exec_lo, s72, s73
    s_bitcmp1_b32 s49, s31
    s_cselect_b32 s72, 0xffff, 0
    s_bitcmp1_b32 s51, s31
    s_cselect_b32 s73, 0xffff0000, 0
    s_or_b32 exec_hi, s72, s73
    v_add_u32 v107, 784, v107
    ds_read2_b32 v[60:61], v107 offset0:196 offset1:212
    ds_read2_b32 v[62:63], v107 offset0:228 offset1:244
L_nosw1:
    s_mov_b64 exec, -1
    s_cmp_gt_u32 s31, s54
    s_cbranch_scc0 L_pr1
    s_setprio 2
    s_cmp_gt_u32 s31, s55
    s_cbranch_scc0 L_pr1
    s_setprio 1
    s_cmp_gt_u32 s31, s56
    s_cbranch_scc0 L_pr1
    s_setprio 0
L_pr1:
    s_cmp_lg_u32 s82, 0
    s_cbranch_scc1 L_loop
    s_branch L_drain
L_h0:
    s_ff1_i32_b32 s31, s82
    s_cmp_eq_u32 s82, 0
    s_cselect_b32 s31, 32, s31
    s_add_u32 s31, s31, s83
    s_add_u32 s73, s31, 3
    s_cmp_gt_u32 s20, s73
    s_cselect_b64 vcc, 1, 0
    s_bitcmp1_b32 s52, s31
    s_cbranch_scc0 L_nofl0
    s_bitcmp1_b32 s44, s31
    s_cselect_b32 s72, 0xffff, 0
    s_bitcmp1_b32 s46, s31
    s_cselect_b32 s73, 0xffff0000, 0
    s_or_b32 exec_lo, s72, s73
    s_bitcmp1_b32 s48, s31
    s_cselect_b32 s72, 0xffff, 0
    s_bitcmp1_b32 s50, s31
    s_cselect_b32 s73, 0xffff0000, 0
    s_or_b32 exec_hi, s72, s73
    ds_write2_b32 v107, v52, v53 offset0:64 offset1:80
    ds_write2_b32 v107, v54, v55 offset0:96 offset1:112
    ds_write2_b32 v107, v56, v57 offset0:128 offset1:144
    ds_write2_b32 v107, v58, v59 offset0:160 offset1:176
    ds_read_b128 v[52:55], v108
    ds_read_b128 v[56:59], v108
L_nofl0:
    s_bitcmp1_b32 s53, s31
    s_cbranch_scc0 L_nosw0
    s_bitcmp1_b32 s45, s31
    s_cselect_b32 s72, 0xffff, 0
    s_bitcmp1_b32 s47, s31
    s_cselect_b32 s73, 0xffff0000, 0
    s_or_b32 exec_lo, s72, s73
    s_bitcmp1_b32 s49, s31
    s_cselect_b32 s72, 0xffff, 0
    s_bitcmp1_b32 s51, s31
    s_cselect_b32 s73, 0xffff0000, 0
    s_or_b32 exec_hi, s72, s73
    v_add_u32 v107, 784, v107
    ds_read2_b32 v[60:61], v107 offset0:196 offset1:212
    ds_read2_b32 v[62:63], v107 offset0:228 offset1:244
L_nosw0:
    s_mov_b64 exec, -1
    s_cmp_gt_u32 s31, s54
    s_cbranch_scc0 L_pr0
    s_setprio 2
    s_cmp_gt_u32 s31, s55
    s_cbranch_scc0 L_pr0
    s_setprio 1
    s_cmp_gt_u32 s31, s56
    s_cbranch_scc0 L_pr0
    s_setprio 0
L_pr0:
    s_cmp_lg_u32 s82, 0
    s_cbranch_scc1 L_r0
    s_branch L_drain
L_skipg0:
    s_waitcnt vmcnt(0)
    s_branch L_backg0
L_skipg1:
    s_waitcnt vmcnt(0)
    s_branch L_backg1
L_drain:
    v_add_u32 v18, 1040, v107
    v_rcp_f32_e32 v40, v40
    v_rcp_f32_e32 v41, v41
    v_rcp_f32_e32 v42, v42
    v_rcp_f32_e32 v43, v43
    s_bitreplicate_b64_b32 s[78:79], s3
    s_bitreplicate_b64_b32 s[78:79], s78
    s_bitreplicate_b64_b32 s[78:79], s78
    s_bitreplicate_b64_b32 s[78:79], s78
    v_cndmask_b32 v17, v125, v18, s[78:79]
    s_mov_b32 s80, 0x00010001
    s_mov_b32 s81, 0x00010001
    s_waitcnt lgkmcnt(0)
    v_pk_fma_f32 v[52:53], v[44:45], v[40:41], v[52:53]
    v_pk_fma_f32 v[54:55], v[46:47], v[42:43], v[54:55]
    v_pk_fma_f32 v[56:57], v[48:49], v[40:41], v[56:57]
    v_pk_fma_f32 v[58:59], v[50:51], v[42:43], v[58:59]
    ds_write2_b32 v17, v52, v53 offset0:0 offset1:16
    ds_write2_b32 v17, v54, v55 offset0:32 offset1:48
    ds_write2_b32 v17, v56, v57 offset0:64 offset1:80
    ds_write2_b32 v17, v58, v59 offset0:96 offset1:112
    s_andn2_b64 exec, s[80:81], s[78:79]
    ds_add_u32 v107, v2 offset:1552
    ds_max_u32 v107, v126 offset:1556
    s_mov_b64 exec, -1
    s_mov_b32 s72, 528
    v_xor_b32 v15, 16, v122
    s_mov_b32 s78, 0x538637bd
    s_mov_b32 s79, 0x538637bd
    s_cmp_lt_u32 s28, 10
    s_waitcnt vmcnt(0)
    s_cbranch_scc0 L_nounp
    v_lshlrev_b32 v76, 16, v116
    v_and_b32 v77, 0xffff0000, v116
    v_lshlrev_b32 v78, 16, v117
    v_and_b32 v79, 0xffff0000, v117
    v_lshlrev_b32 v80, 16, v118
    v_and_b32 v81, 0xffff0000, v118
    v_lshlrev_b32 v82, 16, v119
    v_and_b32 v83, 0xffff0000, v119
L_nounp:
    s_waitcnt lgkmcnt(0)
    s_barrier
    s_cmp_lt_u32 s28, 10
    s_cbranch_scc0 L_nocomb
    ds_read_b64 v[16:17], v124 offset:768
    ds_read_b128 v[24:27], v121 offset:256
    ds_read_b128 v[28:31], v121 offset:272
    ds_read_b128 v[32:35], v121 offset:512
    ds_read_b128 v[36:39], v121 offset:528
    ds_read_b128 v[40:43], v122
    ds_read_b128 v[44:47], v15
    s_mov_b32 s31, 0
    s_waitcnt lgkmcnt(6)
    v_mad_u32_u24 v18, v17, s72, v123
    v_cmp_lt_u32 vcc, 0, v16
L_part:
    s_mov_b64 exec, vcc
    ds_read_b128 v[48:51], v18 offset:0
    ds_read_b128 v[52:55], v18 offset:16
    ds_read_b128 v[56:59], v18 offset:256
    ds_read_b128 v[60:63], v18 offset:272
    s_add_u32 s31, s31, 1
    v_subrev_u32 v18, 528, v18
    v_cmp_lt_u32 vcc, s31, v16
    s_waitcnt lgkmcnt(2)
    v_pk_add_f32 v[24:25], v[24:25], v[48:49]
    v_pk_add_f32 v[26:27], v[26:27], v[50:51]
    v_pk_add_f32 v[28:29], v[28:29], v[52:53]
    v_pk_add_f32 v[30:31], v[30:31], v[54:55]
    s_waitcnt lgkmcnt(0)
    v_pk_add_f32 v[32:33], v[32:33], v[56:57]
    v_pk_add_f32 v[34:35], v[34:35], v[58:59]
    v_pk_add_f32 v[36:37], v[36:37], v[60:61]
    v_pk_add_f32 v[38:39], v[38:39], v[62:63]
    s_cbranch_vccnz L_part
    s_mov_b64 exec, -1
    s_cmp_eq_u32 s17, 0
    s_cbranch_scc0 L_slowcomb
L_final:
    s_waitcnt lgkmcnt(0)
    v_pk_add_f32 v[24:25], v[24:25], s[78:79]
    v_pk_add_f32 v[26:27], v[26:27], s[78:79]
    v_pk_add_f32 v[28:29], v[28:29], s[78:79]
    v_pk_add_f32 v[30:31], v[30:31], s[78:79]
    v_rcp_f32 v24, v24
    v_rcp_f32 v25, v25
    v_rcp_f32 v26, v26
    v_rcp_f32 v27, v27
    v_rcp_f32 v28, v28
    v_rcp_f32 v29, v29
    v_rcp_f32 v30, v30
    v_rcp_f32 v31, v31
    v_pk_fma_f32 v[40:41], v[32:33], v[24:25], v[40:41]
    v_pk_fma_f32 v[42:43], v[34:35], v[26:27], v[42:43]
    v_pk_fma_f32 v[44:45], v[36:37], v[28:29], v[44:45]
    v_pk_fma_f32 v[46:47], v[38:39], v[30:31], v[46:47]
    v_max_f32 v40, 0, v40
    v_max_f32 v41, 0, v41
    v_max_f32 v42, 0, v42
    v_max_f32 v43, 0, v43
    v_max_f32 v44, 0, v44
    v_max_f32 v45, 0, v45
    v_max_f32 v46, 0, v46
    v_max_f32 v47, 0, v47
    v_pk_add_f32 v[40:41], v[40:41], v[76:77]
    v_pk_add_f32 v[42:43], v[42:43], v[78:79]
    v_pk_add_f32 v[44:45], v[44:45], v[80:81]
    v_pk_add_f32 v[46:47], v[46:47], v[82:83]
    v_cvt_pk_bf16_f32 v24, v40, v41
    v_cvt_pk_bf16_f32 v25, v42, v43
    v_cvt_pk_bf16_f32 v26, v44, v45
    v_cvt_pk_bf16_f32 v27, v46, v47
    s_mov_b64 exec, s[34:35]
    global_store_dwordx4 v120, v[24:27], s[22:23] sc0 sc1 nt
L_out_done:
    s_endpgm
L_f2:
    s_mov_b32 s15, 1048576
    s_mov_b64 exec, s[6:7]
    global_load_dwordx2 v[88:89], v109, s[26:27] sc1
L_f2l:
    s_waitcnt vmcnt(0)
    s_mov_b64 exec, s[6:7]
    v_cmp_ne_u32 vcc, s40, v88
    v_cmp_ne_u32 s[78:79], s41, v89
    s_or_b64 vcc, vcc, s[78:79]
    s_cbranch_scc1 L_f2r
    s_mov_b64 exec, s[8:9]
    global_load_dword v117, v119, s[26:27] sc1
    s_mov_b64 s[6:7], 0
    s_branch L_f2_done
L_f2r:
    s_sub_u32 s15, s15, 1
    s_cbranch_scc1 L_f2_done
    s_sleep 1
    global_load_dwordx2 v[88:89], v109, s[26:27] sc1
    s_branch L_f2l
L_goslow:
    ds_read_b32 v56, v4 offset:2184
    s_waitcnt lgkmcnt(0)
    v_readfirstlane_b32 s18, v56
    s_mov_b32 s17, 1
    s_mov_b32 s84, 0x7ff07ff
    s_mov_b32 s85, 0x7ff07ff
    s_waitcnt vmcnt(0)
    s_barrier
    ds_write_b64 v93, v[4:5] offset:1024
    s_waitcnt lgkmcnt(0)
    s_barrier
    s_branch L_nextround2
L_nextround:
    s_mov_b64 s[6:7], 0
    v_lshlrev_b32 v93, 3, v1
    ds_read_b64 v[64:65], v93 offset:2304
    ds_read_b64 v[70:71], v93 offset:2304
    ds_read_b64 v[76:77], v93 offset:2304
    ds_read_b64 v[82:83], v93 offset:2304
L_nextround2:
    s_mov_b32 s82, 0
    s_mov_b64 s[44:45], 0
    s_mov_b64 s[46:47], 0
    s_mov_b64 s[48:49], 0
    s_mov_b64 s[50:51], 0
    s_mov_b64 s[52:53], 0
    s_mov_b64 s[54:55], 0
    s_mov_b64 s[56:57], 0
    s_mov_b64 s[58:59], 0
    s_mov_b64 s[60:61], 0
    s_mov_b64 s[62:63], 0
    s_mov_b64 s[64:65], 0
    s_mov_b64 s[66:67], 0
    s_mov_b64 s[78:79], s[76:77]
    s_mov_b64 s[42:43], s[76:77]
    s_branch L_round
L_nocomb:
    s_cmp_eq_u32 s17, 0
    s_cbranch_scc1 L_out_done
    s_add_u32 s16, s16, 11
    s_cmp_lt_u32 s16, s18
    s_cbranch_scc1 L_nextround
    s_branch L_out_done
L_slowcomb:
    s_mul_i32 s31, s2, 40960
    s_add_u32 s31, s31, 239075328
    s_add_u32 s78, s26, s31
    s_addc_u32 s79, s27, 0
    v_lshlrev_b32 v20, 6, v0
    s_waitcnt lgkmcnt(0)
    ds_write_b64 v124, v[4:5] offset:768
    s_cmp_eq_u32 s16, 0
    s_cbranch_scc1 L_slow1
    global_load_dwordx4 v[48:51], v20, s[78:79] offset:0 sc1
    global_load_dwordx4 v[52:55], v20, s[78:79] offset:16 sc1
    global_load_dwordx4 v[56:59], v20, s[78:79] offset:32 sc1
    global_load_dwordx4 v[60:63], v20, s[78:79] offset:48 sc1
    s_waitcnt vmcnt(0)
    v_pk_add_f32 v[24:25], v[24:25], v[48:49]
    v_pk_add_f32 v[26:27], v[26:27], v[50:51]
    v_pk_add_f32 v[28:29], v[28:29], v[52:53]
    v_pk_add_f32 v[30:31], v[30:31], v[54:55]
    v_pk_add_f32 v[32:33], v[32:33], v[56:57]
    v_pk_add_f32 v[34:35], v[34:35], v[58:59]
    v_pk_add_f32 v[36:37], v[36:37], v[60:61]
    v_pk_add_f32 v[38:39], v[38:39], v[62:63]
L_slow1:
    s_add_u32 s16, s16, 11
    s_cmp_lt_u32 s16, s18
    s_cbranch_scc0 L_final2
    global_store_dwordx4 v20, v[24:27], s[78:79] offset:0 sc1
    global_store_dwordx4 v20, v[28:31], s[78:79] offset:16 sc1
    global_store_dwordx4 v20, v[32:35], s[78:79] offset:32 sc1
    global_store_dwordx4 v20, v[36:39], s[78:79] offset:48 sc1
    s_waitcnt vmcnt(0) lgkmcnt(0)
    s_branch L_nextround
L_giveup:
    v_mov_b32 v112, 0
    s_branch L_polled
L_final2:
    s_mov_b32 s78, 0x538637bd
    s_mov_b32 s79, 0x538637bd
    s_branch L_final
L_end:
    s_endpgm
.section .rodata,"a"
.p2align 6
.amdhsa_kernel standalone__edge_featured_mpnn_gatedgcn__graph_kernel
  .amdhsa_next_free_vgpr 128
  .amdhsa_next_free_sgpr 102
  .amdhsa_accum_offset 128
  .amdhsa_group_segment_fixed_size 0
  .amdhsa_kernarg_size 96
  .amdhsa_user_sgpr_count 2
  .amdhsa_user_sgpr_kernarg_segment_ptr 1
  .amdhsa_system_sgpr_workgroup_id_x 1
.end_amdhsa_kernel
```
